```python
import torch

def _softmax(x, axis=-1):
    return torch.softmax(x, dim=axis)
def _gelu(x):
    return torch.nn.functional.gelu(x, approximate="tanh")
def _silu(x):
    return torch.nn.functional.silu(x)
def _sigmoid(x):
    return torch.sigmoid(x)
def _layernorm(x, axis=-1, eps=1e-5):
    m = x.mean(dim=axis, keepdim=True)
    v = x.var(dim=axis, keepdim=True, unbiased=False)
    return (x - m) / torch.sqrt(v + eps)
def _scatter_add(tgt, idx, src, axis=0):
    return tgt.clone().index_add_(axis, idx, src)
def _segment_sum(src, seg, n):
    out = torch.zeros((n,) + src.shape[1:], dtype=src.dtype)
    return out.index_add_(0, seg, src)
def _pad(x, pw):
    flat = tuple(v for pair in reversed(pw) for v in pair)
    return torch.nn.functional.pad(x, flat)

kernel_name = 'sequential_preLN__mha_block__dense_activation_gelu__prompt'

def setup_inputs():

    _w = (lambda a: (lambda t: t.to(torch.bfloat16) if t.is_floating_point() else t)(torch.as_tensor(a)))
    def _A_setup():
        B, S, D, H = 1, 2048, 576, 32
        return {
            "x": _w((lambda *s: torch.randn(*s, dtype=torch.bfloat16) * 0.05)(B, S, D)),
            "wqkv": _w((lambda *s: torch.randn(*s, dtype=torch.bfloat16) * 0.05)(D, 3 * D)),
            "wo": _w((lambda *s: torch.randn(*s, dtype=torch.bfloat16) * 0.05)(D, D)),
        }
    _A_in = _A_setup()

    def _B_setup():
        B, S, D, F = 1, 2048, 576, 4608
        return {
            "x": _w((lambda *s: torch.randn(*s, dtype=torch.bfloat16) * 0.05)(B, S, D)),
            "w1": _w((lambda *s: torch.randn(*s, dtype=torch.bfloat16) * 1.6)(D, F) * (D ** -0.5)),
            "b1": _w((lambda *s: torch.randn(*s, dtype=torch.bfloat16) * 1.6)(F) * 0.01),
            "w2": _w((lambda *s: torch.randn(*s, dtype=torch.bfloat16) * 0.2)(F, D) * (F ** -0.5)),
            "b2": _w((lambda *s: torch.randn(*s, dtype=torch.bfloat16) * 0.2)(D) * 0.01),
        }
    _B_in = _B_setup()

    return {
        "A_x": _A_in["x"],
        "A_wqkv": _A_in["wqkv"],
        "A_wo": _A_in["wo"],
        "B_x": _B_in["x"],
        "B_w1": _B_in["w1"],
        "B_b1": _B_in["b1"],
        "B_w2": _B_in["w2"],
        "B_b2": _B_in["b2"],
    }

def reference(A_x, A_wqkv, A_wo, B_x, B_w1, B_b1, B_w2, B_b2):
    def _A_ref(x, wqkv, wo):
        B, S, D = x.shape
        H = 32
        Dh = D // H
        qkv = (lambda x, *d: x.permute(*d))((x @ wqkv).reshape(B, S, 3, H, Dh), 2, 0, 3, 1, 4)
        q, k, v = qkv[0], qkv[1], qkv[2]
        scores = torch.einsum("bhqd,bhkd->bhqk", q, k) * (Dh ** -0.5)
        p = _softmax(scores, axis=-1)
        o = torch.einsum("bhqk,bhkd->bhqd", p, v)
        return (lambda x, *d: x.permute(*d))(o, 0, 2, 1, 3).reshape(B, S, D) @ wo

    def _B_ref(x, w1, b1, w2, b2):
        h = torch.einsum("bsd,df->bsf", x, w1) + b1
        h = _gelu(h)
        return torch.einsum("bsf,fd->bsd", h, w2) + b2

    x = A_x
    h = x + _A_ref(_layernorm(x, axis=-1), A_wqkv, A_wo)
    h2 = h + _B_ref(_layernorm(h, axis=-1), B_w1, B_b1, B_w2, B_b2)
    return h2
```

```asm
; @launch grid=(256,1,1) block=(512,1,1) lds=156672
.amdgcn_target "amdgcn-amd-amdhsa--gfx950"
.text
.globl sequential_preLN__mha_block__dense_activation_gelu__prompt_kernel
.p2align 8
.type sequential_preLN__mha_block__dense_activation_gelu__prompt_kernel,@function
sequential_preLN__mha_block__dense_activation_gelu__prompt_kernel:
    s_cmp_ge_u32 s2, 224
    s_cbranch_scc1 Lk1_aux
    s_load_dwordx4 s[4:7], s[0:1], 0
    s_load_dwordx2 s[8:9], s[0:1], 80
    v_lshrrev_b32 v2, 6, v0
    v_and_b32 v1, 63, v0
    v_readfirstlane_b32 s24, v2
    s_and_b32 s3, s2, 7
    s_lshr_b32 s33, s2, 3
    s_lshr_b32 s25, s3, 1
    s_lshl_b32 s25, s25, 2
    s_and_b32 s34, s33, 3
    s_add_u32 s25, s25, s34
    s_and_b32 s26, s3, 1
    s_mul_i32 s26, s26, 7
    s_lshr_b32 s34, s33, 2
    s_add_u32 s26, s26, s34
    s_bfe_u32 s27, s24, 0x10001
    s_and_b32 s28, s24, 1
    s_cmp_lt_u32 s24, 4
    s_cbranch_scc1 Lk1_cw
    s_sub_u32 s24, s24, 4
    s_and_b32 s35, s33, 3
    s_mul_i32 s35, s35, 2
    s_mul_i32 s34, s34, 1
    s_add_u32 s42, s34, s35
    s_cmp_ge_u32 s42, 9
    s_cselect_b32 s35, 9, 0
    s_sub_u32 s42, s42, s35
    v_lshrrev_b32 v28, 4, v1
    v_lshlrev_b32 v28, 4, v28
    v_bfe_u32 v29, v1, 3, 1
    v_add_u32 v28, v28, v29
    s_lshl_b32 s34, s27, 6
    s_lshl_b32 s35, s28, 3
    s_add_u32 s34, s34, s35
    v_add_u32 v28, s34, v28
    v_mul_u32_u24 v28, 1152, v28
    v_and_b32 v29, 7, v1
    v_lshl_add_u32 v2, v29, 4, v28
    v_add_u32 v3, 1264, v2
    v_add_u32 v4, 2528, v2
    v_add_u32 v5, 3792, v2
    v_lshrrev_b32 v28, 4, v1
    v_lshlrev_b32 v29, 2, v28
    v_and_b32 v30, 15, v1
    v_xor_b32 v29, v29, v30
    s_lshl_b32 s34, s24, 4
    v_add_u32 v28, s34, v28
    v_mul_u32_u24 v28, 3456, v28
    v_lshl_add_u32 v6, v29, 4, v28
    v_add_u32 v7, 12800, v6
    v_add_u32 v8, 25600, v6
    v_add_u32 v9, 38400, v6
    s_mul_i32 s29, s25, 147456
    s_lshl_b32 s30, s26, 8
    s_max_u32 s32, s26, 9
    s_lshl_b32 s32, s32, 2
    s_sub_u32 s32, s32, 36
    s_sub_u32 s30, s30, s32
    s_mul_i32 s32, s24, 4160
    s_lshl_b32 s36, s24, 12
    s_add_u32 s36, s36, 16640
    s_waitcnt lgkmcnt(0)
    s_mov_b32 s12, s4
    s_mov_b32 s13, s5
    s_mov_b32 s14, 0x240000
    s_mov_b32 s15, 0x20000
    s_mov_b32 s16, s6
    s_mov_b32 s17, s7
    s_mov_b32 s18, 0x1e6000
    s_mov_b32 s19, 0x20000
    s_lshl_b32 s34, s42, 7
    s_add_u32 s29, s29, s34
    s_mul_i32 s34, s42, 221184
    s_add_u32 s30, s30, s34
    s_mov_b32 s31, 0
Lk1_dma:
    s_mov_b32 m0, s32
    s_nop 0
    buffer_load_dwordx4 v2, s[12:15], s29 offen offset:0 lds
    buffer_load_dwordx4 v3, s[12:15], s29 offen offset:1040 lds
    buffer_load_dwordx4 v4, s[12:15], s29 offen offset:2080 lds
    buffer_load_dwordx4 v5, s[12:15], s29 offen offset:3120 lds
    s_mov_b32 m0, s36
    s_nop 0
    buffer_load_dwordx4 v6, s[16:19], s30 offen offset:0 lds
    buffer_load_dwordx4 v7, s[16:19], s30 offen offset:1024 lds
    buffer_load_dwordx4 v8, s[16:19], s30 offen offset:2048 lds
    buffer_load_dwordx4 v9, s[16:19], s30 offen offset:3072 lds
    s_add_u32 s42, s42, 1
    s_cmp_eq_u32 s42, 9
    s_cselect_b32 s34, -8, 1
    s_lshl_b32 s35, s34, 7
    s_add_u32 s29, s29, s35
    s_mul_i32 s35, s34, 221184
    s_add_u32 s30, s30, s35
    s_and_b32 s34, s31, 3
    s_cmp_eq_u32 s34, 3
    s_cselect_b32 s34, -3, 1
    s_mul_i32 s34, s34, 33024
    s_add_u32 s32, s32, s34
    s_add_u32 s36, s36, s34
    s_add_u32 s31, s31, 1
    s_cmp_lt_u32 s31, 2
    s_cbranch_scc1 Lk1_dma
    s_cmp_gt_u32 s31, 2
    s_cbranch_scc1 Lk1_d2
    s_waitcnt vmcnt(8)
    s_barrier
    s_branch Lk1_dma
Lk1_d2:
    s_cmp_lt_u32 s31, 4
    s_cbranch_scc1 Lk1_dma
    s_waitcnt vmcnt(16)
    s_barrier
    s_cmp_lt_u32 s31, 9
    s_cbranch_scc1 Lk1_dma
    s_waitcnt vmcnt(8)
    s_barrier
    s_waitcnt vmcnt(0)
    s_barrier
    s_lshl_b32 s61, s26, 4
    s_add_u32 s61, s61, s25
    s_load_dwordx2 s[10:11], s[0:1], 72
    s_waitcnt lgkmcnt(0)
    s_mov_b32 s20, s10
    s_mov_b32 s21, s11
    s_mov_b32 s22, 0x100
    s_mov_b32 s23, 0x20000
    v_and_b32 v30, 31, v1
    v_lshlrev_b32 v30, 2, v30
    v_mov_b32 v31, 1
    s_cmp_eq_u32 s24, 0
    s_cbranch_scc0 Ljoin
    buffer_load_dword v31, v30, s[20:23], 0 offen sc1
    s_branch Ljoin
Lk1_cw:
    v_and_b32 v28, 31, v1
    v_and_b32 v29, 0x13, v1
    v_bfe_u32 v30, v1, 2, 1
    v_lshl_or_b32 v29, v30, 3, v29
    v_bfe_u32 v30, v1, 3, 1
    v_lshl_or_b32 v29, v30, 2, v29
    s_cmp_ge_u32 s26, 9
    s_cselect_b64 vcc, -1, 0
    v_cndmask_b32 v31, v28, v29, vcc
    v_bfe_u32 v28, v31, 1, 3
    v_mul_u32_u24 v28, 1040, v28
    v_and_b32 v29, 1, v31
    v_lshl_add_u32 v28, v29, 7, v28
    v_lshrrev_b32 v29, 4, v31
    v_lshl_add_u32 v28, v29, 8, v28
    v_lshrrev_b32 v29, 5, v1
    v_lshl_add_u32 v28, v29, 4, v28
    s_mul_i32 s34, s27, 8320
    s_lshl_b32 s35, s28, 9
    s_add_u32 s37, s34, s35
    v_add_u32 v10, s37, v28
    s_xor_b32 s35, s35, 512
    s_add_u32 s37, s34, s35
    v_add_u32 v11, s37, v28
    v_bfe_u32 v28, v1, 2, 2
    v_lshrrev_b32 v29, 5, v1
    v_lshl_add_u32 v29, v29, 3, v28
    v_lshlrev_b32 v29, 8, v29
    v_bfe_u32 v30, v1, 4, 1
    v_lshl_add_u32 v29, v30, 5, v29
    v_and_b32 v30, 3, v1
    v_lshl_add_u32 v29, v30, 3, v29
    v_add_u32 v29, 16640, v29
    s_lshl_b32 s34, s28, 1
    s_add_u32 s34, s34, s27
    v_xor_b32 v30, s34, v28
    v_lshl_add_u32 v12, v30, 6, v29
    v_xor_b32 v30, 1, v30
    v_lshl_add_u32 v13, v30, 6, v29
    v_bfe_u32 v28, v1, 2, 1
    v_bfe_u32 v29, v1, 4, 1
    v_cmp_eq_u32 vcc, v28, v29
    v_mov_b32 v30, 0x3f803f80
    v_mov_b32 v14, 0
    v_mov_b32 v15, 0
    v_cndmask_b32 v16, 0, v30, vcc
    v_cndmask_b32 v17, 0, v30, vcc
    v_cndmask_b32 v18, 0, v30, vcc
    v_cndmask_b32 v19, 0, v30, vcc
    v_mov_b32 v20, 0
    v_mov_b32 v21, 0
    v_mov_b32 v22, 0
    v_mov_b32 v23, 0
    v_mov_b32 v24, 0
    v_mov_b32 v25, 0
    v_mov_b32 v26, 0
    v_mov_b32 v27, 0
    v_mov_b32 v64, 0
    v_mov_b32 v65, 0
    v_mov_b32 v66, 0
    v_mov_b32 v67, 0
    v_mov_b32 v68, 0
    v_mov_b32 v69, 0
    v_mov_b32 v70, 0
    v_mov_b32 v71, 0
    v_mov_b32 v72, 0
    v_mov_b32 v73, 0
    v_mov_b32 v74, 0
    v_mov_b32 v75, 0
    v_mov_b32 v76, 0
    v_mov_b32 v77, 0
    v_mov_b32 v78, 0
    v_mov_b32 v79, 0
    v_mov_b32 v80, 0
    v_mov_b32 v81, 0
    v_mov_b32 v82, 0
    v_mov_b32 v83, 0
    v_mov_b32 v84, 0
    v_mov_b32 v85, 0
    v_mov_b32 v86, 0
    v_mov_b32 v87, 0
    v_mov_b32 v88, 0
    v_mov_b32 v89, 0
    v_mov_b32 v90, 0
    v_mov_b32 v91, 0
    v_mov_b32 v92, 0
    v_mov_b32 v93, 0
    v_mov_b32 v94, 0
    v_mov_b32 v95, 0
    v_mov_b32 v96, 0
    v_mov_b32 v97, 0
    v_mov_b32 v98, 0
    v_mov_b32 v99, 0
    v_mov_b32 v100, 0
    v_mov_b32 v101, 0
    v_mov_b32 v102, 0
    v_mov_b32 v103, 0
    v_mov_b32 v104, 0
    v_mov_b32 v105, 0
    v_mov_b32 v106, 0
    v_mov_b32 v107, 0
    v_mov_b32 v108, 0
    v_mov_b32 v109, 0
    v_mov_b32 v110, 0
    v_mov_b32 v111, 0
    v_mov_b32 v112, 0
    v_mov_b32 v113, 0
    v_mov_b32 v114, 0
    v_mov_b32 v115, 0
    v_mov_b32 v116, 0
    v_mov_b32 v117, 0
    v_mov_b32 v118, 0
    v_mov_b32 v119, 0
    v_mov_b32 v120, 0
    v_mov_b32 v121, 0
    v_mov_b32 v122, 0
    v_mov_b32 v123, 0
    v_mov_b32 v124, 0
    v_mov_b32 v125, 0
    v_mov_b32 v126, 0
    v_mov_b32 v127, 0
    s_mov_b32 s31, 0
    s_mov_b32 s38, 0xffff0000
    s_mov_b32 s39, 33024
    s_waitcnt lgkmcnt(0)
    s_barrier
    s_setprio 1
    ds_read_b128 v[32:35], v10 offset:0
    ds_read_b64_tr_b16 v[40:41], v12 offset:0
    ds_read_b64_tr_b16 v[42:43], v12 offset:1024
    ds_read_b128 v[36:39], v11 offset:0
    ds_read_b64_tr_b16 v[44:45], v13 offset:0
    ds_read_b64_tr_b16 v[46:47], v13 offset:1024
    s_cmp_ge_u32 s26, 9
    s_cbranch_scc1 Lk1_loop1
Lk1_loop0:
    s_waitcnt lgkmcnt(0)
    v_mfma_f32_32x32x16_bf16 v[64:79], v[40:43], v[32:35], v[64:79]
    ds_read_b128 v[48:51], v10 offset:32
    ds_read_b64_tr_b16 v[56:57], v12 offset:4096
    ds_read_b64_tr_b16 v[58:59], v12 offset:5120
    v_mfma_f32_32x32x16_bf16 v[80:95], v[40:43], v[36:39], v[80:95]
    ds_read_b128 v[52:55], v11 offset:32
    ds_read_b64_tr_b16 v[60:61], v13 offset:4096
    ds_read_b64_tr_b16 v[62:63], v13 offset:5120
    v_mfma_f32_32x32x16_bf16 v[96:111], v[44:47], v[32:35], v[96:111]
    v_lshlrev_b32 v28, 16, v32
    v_and_b32 v29, s38, v32
    v_fmac_f32 v14, v28, v28
    v_fmac_f32 v15, v29, v29
    v_lshlrev_b32 v28, 16, v33
    v_and_b32 v29, s38, v33
    v_fmac_f32 v14, v28, v28
    v_fmac_f32 v15, v29, v29
    v_mfma_f32_32x32x16_bf16 v[112:127], v[44:47], v[36:39], v[112:127]
    v_lshlrev_b32 v28, 16, v34
    v_and_b32 v29, s38, v34
    v_fmac_f32 v14, v28, v28
    v_fmac_f32 v15, v29, v29
    v_lshlrev_b32 v28, 16, v35
    v_and_b32 v29, s38, v35
    v_fmac_f32 v14, v28, v28
    v_fmac_f32 v15, v29, v29
    v_mfma_f32_16x16x32_bf16 v[20:23], v[16:19], v[32:35], v[20:23]
    v_mfma_f32_16x16x32_bf16 v[24:27], v[16:19], v[40:43], v[24:27]
    s_waitcnt lgkmcnt(0)
    v_mfma_f32_32x32x16_bf16 v[64:79], v[56:59], v[48:51], v[64:79]
    ds_read_b128 v[32:35], v10 offset:64
    ds_read_b64_tr_b16 v[40:41], v12 offset:8192
    ds_read_b64_tr_b16 v[42:43], v12 offset:9216
    v_mfma_f32_32x32x16_bf16 v[80:95], v[56:59], v[52:55], v[80:95]
    ds_read_b128 v[36:39], v11 offset:64
    ds_read_b64_tr_b16 v[44:45], v13 offset:8192
    ds_read_b64_tr_b16 v[46:47], v13 offset:9216
    v_mfma_f32_32x32x16_bf16 v[96:111], v[60:63], v[48:51], v[96:111]
    v_lshlrev_b32 v28, 16, v48
    v_and_b32 v29, s38, v48
    v_fmac_f32 v14, v28, v28
    v_fmac_f32 v15, v29, v29
    v_lshlrev_b32 v28, 16, v49
    v_and_b32 v29, s38, v49
    v_fmac_f32 v14, v28, v28
    v_fmac_f32 v15, v29, v29
    v_mfma_f32_32x32x16_bf16 v[112:127], v[60:63], v[52:55], v[112:127]
    v_lshlrev_b32 v28, 16, v50
    v_and_b32 v29, s38, v50
    v_fmac_f32 v14, v28, v28
    v_fmac_f32 v15, v29, v29
    v_lshlrev_b32 v28, 16, v51
    v_and_b32 v29, s38, v51
    v_fmac_f32 v14, v28, v28
    v_fmac_f32 v15, v29, v29
    v_mfma_f32_16x16x32_bf16 v[20:23], v[16:19], v[48:51], v[20:23]
    v_mfma_f32_16x16x32_bf16 v[24:27], v[16:19], v[56:59], v[24:27]
    s_waitcnt lgkmcnt(0)
    v_mfma_f32_32x32x16_bf16 v[64:79], v[40:43], v[32:35], v[64:79]
    ds_read_b128 v[48:51], v10 offset:96
    ds_read_b64_tr_b16 v[56:57], v12 offset:12288
    ds_read_b64_tr_b16 v[58:59], v12 offset:13312
    v_mfma_f32_32x32x16_bf16 v[80:95], v[40:43], v[36:39], v[80:95]
    ds_read_b128 v[52:55], v11 offset:96
    ds_read_b64_tr_b16 v[60:61], v13 offset:12288
    ds_read_b64_tr_b16 v[62:63], v13 offset:13312
    v_mfma_f32_32x32x16_bf16 v[96:111], v[44:47], v[32:35], v[96:111]
    v_lshlrev_b32 v28, 16, v32
    v_and_b32 v29, s38, v32
    v_fmac_f32 v14, v28, v28
    v_fmac_f32 v15, v29, v29
    v_lshlrev_b32 v28, 16, v33
    v_and_b32 v29, s38, v33
    v_fmac_f32 v14, v28, v28
    v_fmac_f32 v15, v29, v29
    v_mfma_f32_32x32x16_bf16 v[112:127], v[44:47], v[36:39], v[112:127]
    v_lshlrev_b32 v28, 16, v34
    v_and_b32 v29, s38, v34
    v_fmac_f32 v14, v28, v28
    v_fmac_f32 v15, v29, v29
    v_lshlrev_b32 v28, 16, v35
    v_and_b32 v29, s38, v35
    v_fmac_f32 v14, v28, v28
    v_fmac_f32 v15, v29, v29
    v_mfma_f32_16x16x32_bf16 v[20:23], v[16:19], v[32:35], v[20:23]
    v_mfma_f32_16x16x32_bf16 v[24:27], v[16:19], v[40:43], v[24:27]
    s_and_b32 s34, s31, 3
    s_cmp_eq_u32 s34, 3
    s_cselect_b32 s35, 4294868224, s39
    v_add_u32 v10, s35, v10
    v_add_u32 v11, s35, v11
    v_add_u32 v12, s35, v12
    v_add_u32 v13, s35, v13
    s_waitcnt lgkmcnt(0)
    s_barrier
    v_mfma_f32_32x32x16_bf16 v[64:79], v[56:59], v[48:51], v[64:79]
    ds_read_b128 v[32:35], v10 offset:0
    ds_read_b64_tr_b16 v[40:41], v12 offset:0
    ds_read_b64_tr_b16 v[42:43], v12 offset:1024
    v_mfma_f32_32x32x16_bf16 v[80:95], v[56:59], v[52:55], v[80:95]
    ds_read_b128 v[36:39], v11 offset:0
    ds_read_b64_tr_b16 v[44:45], v13 offset:0
    ds_read_b64_tr_b16 v[46:47], v13 offset:1024
    v_mfma_f32_32x32x16_bf16 v[96:111], v[60:63], v[48:51], v[96:111]
    v_lshlrev_b32 v28, 16, v48
    v_and_b32 v29, s38, v48
    v_fmac_f32 v14, v28, v28
    v_fmac_f32 v15, v29, v29
    v_lshlrev_b32 v28, 16, v49
    v_and_b32 v29, s38, v49
    v_fmac_f32 v14, v28, v28
    v_fmac_f32 v15, v29, v29
    v_mfma_f32_32x32x16_bf16 v[112:127], v[60:63], v[52:55], v[112:127]
    v_lshlrev_b32 v28, 16, v50
    v_and_b32 v29, s38, v50
    v_fmac_f32 v14, v28, v28
    v_fmac_f32 v15, v29, v29
    v_lshlrev_b32 v28, 16, v51
    v_and_b32 v29, s38, v51
    v_fmac_f32 v14, v28, v28
    v_fmac_f32 v15, v29, v29
    v_mfma_f32_16x16x32_bf16 v[20:23], v[16:19], v[48:51], v[20:23]
    v_mfma_f32_16x16x32_bf16 v[24:27], v[16:19], v[56:59], v[24:27]
    s_add_u32 s31, s31, 1
    s_cmp_lt_u32 s31, 9
    s_cbranch_scc1 Lk1_loop0
    s_waitcnt vmcnt(0) lgkmcnt(0)
    v_add_f32 v14, v14, v15
    v_mov_b32 v15, v14
    s_lshl_b32 s34, s27, 6
    s_lshl_b32 s35, s28, 5
    s_add_u32 s34, s34, s35
    v_add_u32 v32, s34, v31
    v_lshlrev_b32 v32, 2, v32
    v_add_u32 v32, 132096, v32
    v_permlane32_swap_b32 v14, v15
    s_lshl_b32 s34, s28, 6
    s_lshl_b32 s35, s27, 5
    s_add_u32 s34, s34, s35
    v_and_b32 v33, 31, v1
    v_add_u32 v33, s34, v33
    v_lshlrev_b32 v33, 2, v33
    v_add_u32 v33, 132096, v33
    v_add_f32 v14, v14, v15
    v_mul_f32 v20, 0xbae38e39, v20
    v_mul_f32 v14, 0x3ae38e39, v14
    v_fma_f32 v14, -v20, v20, v14
    v_max_f32 v14, 0, v14
    v_add_f32 v14, 0x3727c5ac, v14
    v_rsq_f32 v14, v14
    ds_write_b32 v32, v20
    ds_write_b32 v33, v24 offset:1024
    s_lshl_b32 s34, s26, 1
    s_add_u32 s34, s34, s28
    s_cmp_lt_u32 s34, 9
    s_cselect_b32 s35, 0x3eae1a93, 1.0
    ds_write_b32 v32, v14 offset:512
    v_xor_b32 v32, 128, v32
    v_xor_b32 v33, 128, v33
    s_waitcnt lgkmcnt(0)
    s_barrier
    ds_read_b32 v21, v32
    ds_read_b32 v25, v33 offset:1024
    ds_read_b32 v15, v32 offset:512
    v_cmp_gt_u32 vcc, 32, v1
    s_nop 1
    v_cndmask_b32 v34, 0, v20, vcc
    v_and_b32 v35, s38, v34
    v_sub_f32 v36, v34, v35
    v_cvt_pk_bf16_f32 v40, v35, v35
    v_cvt_pk_bf16_f32 v41, v36, v36
    v_and_b32 v35, s38, v24
    v_sub_f32 v36, v24, v35
    v_cvt_pk_bf16_f32 v44, v35, v36
    v_cvt_pk_bf16_f32 v45, v35, v36
    s_waitcnt lgkmcnt(1)
    v_cndmask_b32 v34, 0, v21, vcc
    v_and_b32 v35, s38, v34
    v_sub_f32 v36, v34, v35
    v_cvt_pk_bf16_f32 v42, v35, v35
    v_cvt_pk_bf16_f32 v43, v36, v36
    v_and_b32 v35, s38, v25
    v_sub_f32 v36, v25, v35
    v_cvt_pk_bf16_f32 v46, v35, v36
    v_cvt_pk_bf16_f32 v47, v35, v36
    v_mfma_f32_32x32x8_bf16 v[64:79], v[44:45], v[40:41], v[64:79]
    v_mfma_f32_32x32x8_bf16 v[80:95], v[44:45], v[42:43], v[80:95]
    v_mfma_f32_32x32x8_bf16 v[96:111], v[46:47], v[40:41], v[96:111]
    v_mfma_f32_32x32x8_bf16 v[112:127], v[46:47], v[42:43], v[112:127]
    s_mov_b32 s20, s8
    s_mov_b32 s21, s9
    s_mov_b32 s22, 0x480000
    s_mov_b32 s23, 0x20000
    s_waitcnt lgkmcnt(0)
    v_mul_f32 v48, s35, v14
    v_mul_f32 v50, s35, v15
    v_lshrrev_b32 v28, 5, v1
    v_lshlrev_b32 v28, 14, v28
    v_and_b32 v29, 31, v1
    v_lshl_add_u32 v28, v29, 3, v28
    s_lshl_b32 s34, s28, 8
    v_add_u32 v28, s34, v28
    v_xor_b32 v29, 256, v28
    s_lshl_b32 s34, s26, 5
    s_lshl_b32 s35, s28, 4
    s_add_u32 s34, s34, s35
    s_lshl_b32 s35, s27, 3
    s_add_u32 s34, s34, s35
    s_lshl_b32 s40, s34, 14
    s_lshl_b32 s35, s25, 10
    s_add_u32 s40, s40, s35
    s_lshl_b32 s35, s27, 9
    s_add_u32 s40, s40, s35
    s_xor_b32 s41, s40, 131072
    v_pk_mul_f32 v[64:65], v[64:65], v[48:49] op_sel_hi:[1,0]
    v_pk_mul_f32 v[66:67], v[66:67], v[48:49] op_sel_hi:[1,0]
    v_pk_mul_f32 v[80:81], v[80:81], v[50:51] op_sel_hi:[1,0]
    v_pk_mul_f32 v[82:83], v[82:83], v[50:51] op_sel_hi:[1,0]
    v_cvt_pk_bf16_f32 v64, v64, v65
    v_cvt_pk_bf16_f32 v65, v66, v67
    buffer_store_dwordx2 v[64:65], v28, s[20:23], s40 offen sc1
    v_cvt_pk_bf16_f32 v80, v80, v81
    v_cvt_pk_bf16_f32 v81, v82, v83
    buffer_store_dwordx2 v[80:81], v29, s[20:23], s40 offen sc1
    s_add_u32 s40, s40, 32768
    v_pk_mul_f32 v[68:69], v[68:69], v[48:49] op_sel_hi:[1,0]
    v_pk_mul_f32 v[70:71], v[70:71], v[48:49] op_sel_hi:[1,0]
    v_pk_mul_f32 v[84:85], v[84:85], v[50:51] op_sel_hi:[1,0]
    v_pk_mul_f32 v[86:87], v[86:87], v[50:51] op_sel_hi:[1,0]
    v_cvt_pk_bf16_f32 v68, v68, v69
    v_cvt_pk_bf16_f32 v69, v70, v71
    buffer_store_dwordx2 v[68:69], v28, s[20:23], s40 offen sc1
    v_cvt_pk_bf16_f32 v84, v84, v85
    v_cvt_pk_bf16_f32 v85, v86, v87
    buffer_store_dwordx2 v[84:85], v29, s[20:23], s40 offen sc1
    s_add_u32 s40, s40, 32768
    v_pk_mul_f32 v[72:73], v[72:73], v[48:49] op_sel_hi:[1,0]
    v_pk_mul_f32 v[74:75], v[74:75], v[48:49] op_sel_hi:[1,0]
    v_pk_mul_f32 v[88:89], v[88:89], v[50:51] op_sel_hi:[1,0]
    v_pk_mul_f32 v[90:91], v[90:91], v[50:51] op_sel_hi:[1,0]
    v_cvt_pk_bf16_f32 v72, v72, v73
    v_cvt_pk_bf16_f32 v73, v74, v75
    buffer_store_dwordx2 v[72:73], v28, s[20:23], s40 offen sc1
    v_cvt_pk_bf16_f32 v88, v88, v89
    v_cvt_pk_bf16_f32 v89, v90, v91
    buffer_store_dwordx2 v[88:89], v29, s[20:23], s40 offen sc1
    s_add_u32 s40, s40, 32768
    v_pk_mul_f32 v[76:77], v[76:77], v[48:49] op_sel_hi:[1,0]
    v_pk_mul_f32 v[78:79], v[78:79], v[48:49] op_sel_hi:[1,0]
    v_pk_mul_f32 v[92:93], v[92:93], v[50:51] op_sel_hi:[1,0]
    v_pk_mul_f32 v[94:95], v[94:95], v[50:51] op_sel_hi:[1,0]
    v_cvt_pk_bf16_f32 v76, v76, v77
    v_cvt_pk_bf16_f32 v77, v78, v79
    buffer_store_dwordx2 v[76:77], v28, s[20:23], s40 offen sc1
    v_cvt_pk_bf16_f32 v92, v92, v93
    v_cvt_pk_bf16_f32 v93, v94, v95
    buffer_store_dwordx2 v[92:93], v29, s[20:23], s40 offen sc1
    v_pk_mul_f32 v[96:97], v[96:97], v[48:49] op_sel_hi:[1,0]
    v_pk_mul_f32 v[98:99], v[98:99], v[48:49] op_sel_hi:[1,0]
    v_pk_mul_f32 v[112:113], v[112:113], v[50:51] op_sel_hi:[1,0]
    v_pk_mul_f32 v[114:115], v[114:115], v[50:51] op_sel_hi:[1,0]
    v_cvt_pk_bf16_f32 v96, v96, v97
    v_cvt_pk_bf16_f32 v97, v98, v99
    buffer_store_dwordx2 v[96:97], v28, s[20:23], s41 offen sc1
    v_cvt_pk_bf16_f32 v112, v112, v113
    v_cvt_pk_bf16_f32 v113, v114, v115
    buffer_store_dwordx2 v[112:113], v29, s[20:23], s41 offen sc1
    s_add_u32 s41, s41, 32768
    v_pk_mul_f32 v[100:101], v[100:101], v[48:49] op_sel_hi:[1,0]
    v_pk_mul_f32 v[102:103], v[102:103], v[48:49] op_sel_hi:[1,0]
    v_pk_mul_f32 v[116:117], v[116:117], v[50:51] op_sel_hi:[1,0]
    v_pk_mul_f32 v[118:119], v[118:119], v[50:51] op_sel_hi:[1,0]
    v_cvt_pk_bf16_f32 v100, v100, v101
    v_cvt_pk_bf16_f32 v101, v102, v103
    buffer_store_dwordx2 v[100:101], v28, s[20:23], s41 offen sc1
    v_cvt_pk_bf16_f32 v116, v116, v117
    v_cvt_pk_bf16_f32 v117, v118, v119
    buffer_store_dwordx2 v[116:117], v29, s[20:23], s41 offen sc1
    s_add_u32 s41, s41, 32768
    v_pk_mul_f32 v[104:105], v[104:105], v[48:49] op_sel_hi:[1,0]
    v_pk_mul_f32 v[106:107], v[106:107], v[48:49] op_sel_hi:[1,0]
    v_pk_mul_f32 v[120:121], v[120:121], v[50:51] op_sel_hi:[1,0]
    v_pk_mul_f32 v[122:123], v[122:123], v[50:51] op_sel_hi:[1,0]
    v_cvt_pk_bf16_f32 v104, v104, v105
    v_cvt_pk_bf16_f32 v105, v106, v107
    buffer_store_dwordx2 v[104:105], v28, s[20:23], s41 offen sc1
    v_cvt_pk_bf16_f32 v120, v120, v121
    v_cvt_pk_bf16_f32 v121, v122, v123
    buffer_store_dwordx2 v[120:121], v29, s[20:23], s41 offen sc1
    s_add_u32 s41, s41, 32768
    v_pk_mul_f32 v[108:109], v[108:109], v[48:49] op_sel_hi:[1,0]
    v_pk_mul_f32 v[110:111], v[110:111], v[48:49] op_sel_hi:[1,0]
    v_pk_mul_f32 v[124:125], v[124:125], v[50:51] op_sel_hi:[1,0]
    v_pk_mul_f32 v[126:127], v[126:127], v[50:51] op_sel_hi:[1,0]
    v_cvt_pk_bf16_f32 v108, v108, v109
    v_cvt_pk_bf16_f32 v109, v110, v111
    buffer_store_dwordx2 v[108:109], v28, s[20:23], s41 offen sc1
    v_cvt_pk_bf16_f32 v124, v124, v125
    v_cvt_pk_bf16_f32 v125, v126, v127
    buffer_store_dwordx2 v[124:125], v29, s[20:23], s41 offen sc1
    s_branch Ljoin
Lk1_loop1:
    s_waitcnt lgkmcnt(0)
    v_mfma_f32_32x32x16_bf16 v[64:79], v[32:35], v[40:43], v[64:79]
    ds_read_b128 v[48:51], v10 offset:32
    ds_read_b64_tr_b16 v[56:57], v12 offset:4096
    ds_read_b64_tr_b16 v[58:59], v12 offset:5120
    v_mfma_f32_32x32x16_bf16 v[80:95], v[36:39], v[40:43], v[80:95]
    ds_read_b128 v[52:55], v11 offset:32
    ds_read_b64_tr_b16 v[60:61], v13 offset:4096
    ds_read_b64_tr_b16 v[62:63], v13 offset:5120
    v_mfma_f32_32x32x16_bf16 v[96:111], v[32:35], v[44:47], v[96:111]
    v_lshlrev_b32 v28, 16, v32
    v_and_b32 v29, s38, v32
    v_fmac_f32 v14, v28, v28
    v_fmac_f32 v15, v29, v29
    v_lshlrev_b32 v28, 16, v33
    v_and_b32 v29, s38, v33
    v_fmac_f32 v14, v28, v28
    v_fmac_f32 v15, v29, v29
    v_mfma_f32_32x32x16_bf16 v[112:127], v[36:39], v[44:47], v[112:127]
    v_lshlrev_b32 v28, 16, v34
    v_and_b32 v29, s38, v34
    v_fmac_f32 v14, v28, v28
    v_fmac_f32 v15, v29, v29
    v_lshlrev_b32 v28, 16, v35
    v_and_b32 v29, s38, v35
    v_fmac_f32 v14, v28, v28
    v_fmac_f32 v15, v29, v29
    v_mfma_f32_16x16x32_bf16 v[20:23], v[16:19], v[32:35], v[20:23]
    v_mfma_f32_16x16x32_bf16 v[24:27], v[16:19], v[40:43], v[24:27]
    s_waitcnt lgkmcnt(0)
    v_mfma_f32_32x32x16_bf16 v[64:79], v[48:51], v[56:59], v[64:79]
    ds_read_b128 v[32:35], v10 offset:64
    ds_read_b64_tr_b16 v[40:41], v12 offset:8192
    ds_read_b64_tr_b16 v[42:43], v12 offset:9216
    v_mfma_f32_32x32x16_bf16 v[80:95], v[52:55], v[56:59], v[80:95]
    ds_read_b128 v[36:39], v11 offset:64
    ds_read_b64_tr_b16 v[44:45], v13 offset:8192
    ds_read_b64_tr_b16 v[46:47], v13 offset:9216
    v_mfma_f32_32x32x16_bf16 v[96:111], v[48:51], v[60:63], v[96:111]
    v_lshlrev_b32 v28, 16, v48
    v_and_b32 v29, s38, v48
    v_fmac_f32 v14, v28, v28
    v_fmac_f32 v15, v29, v29
    v_lshlrev_b32 v28, 16, v49
    v_and_b32 v29, s38, v49
    v_fmac_f32 v14, v28, v28
    v_fmac_f32 v15, v29, v29
    v_mfma_f32_32x32x16_bf16 v[112:127], v[52:55], v[60:63], v[112:127]
    v_lshlrev_b32 v28, 16, v50
    v_and_b32 v29, s38, v50
    v_fmac_f32 v14, v28, v28
    v_fmac_f32 v15, v29, v29
    v_lshlrev_b32 v28, 16, v51
    v_and_b32 v29, s38, v51
    v_fmac_f32 v14, v28, v28
    v_fmac_f32 v15, v29, v29
    v_mfma_f32_16x16x32_bf16 v[20:23], v[16:19], v[48:51], v[20:23]
    v_mfma_f32_16x16x32_bf16 v[24:27], v[16:19], v[56:59], v[24:27]
    s_waitcnt lgkmcnt(0)
    v_mfma_f32_32x32x16_bf16 v[64:79], v[32:35], v[40:43], v[64:79]
    ds_read_b128 v[48:51], v10 offset:96
    ds_read_b64_tr_b16 v[56:57], v12 offset:12288
    ds_read_b64_tr_b16 v[58:59], v12 offset:13312
    v_mfma_f32_32x32x16_bf16 v[80:95], v[36:39], v[40:43], v[80:95]
    ds_read_b128 v[52:55], v11 offset:96
    ds_read_b64_tr_b16 v[60:61], v13 offset:12288
    ds_read_b64_tr_b16 v[62:63], v13 offset:13312
    v_mfma_f32_32x32x16_bf16 v[96:111], v[32:35], v[44:47], v[96:111]
    v_lshlrev_b32 v28, 16, v32
    v_and_b32 v29, s38, v32
    v_fmac_f32 v14, v28, v28
    v_fmac_f32 v15, v29, v29
    v_lshlrev_b32 v28, 16, v33
    v_and_b32 v29, s38, v33
    v_fmac_f32 v14, v28, v28
    v_fmac_f32 v15, v29, v29
    v_mfma_f32_32x32x16_bf16 v[112:127], v[36:39], v[44:47], v[112:127]
    v_lshlrev_b32 v28, 16, v34
    v_and_b32 v29, s38, v34
    v_fmac_f32 v14, v28, v28
    v_fmac_f32 v15, v29, v29
    v_lshlrev_b32 v28, 16, v35
    v_and_b32 v29, s38, v35
    v_fmac_f32 v14, v28, v28
    v_fmac_f32 v15, v29, v29
    v_mfma_f32_16x16x32_bf16 v[20:23], v[16:19], v[32:35], v[20:23]
    v_mfma_f32_16x16x32_bf16 v[24:27], v[16:19], v[40:43], v[24:27]
    s_and_b32 s34, s31, 3
    s_cmp_eq_u32 s34, 3
    s_cselect_b32 s35, 4294868224, s39
    v_add_u32 v10, s35, v10
    v_add_u32 v11, s35, v11
    v_add_u32 v12, s35, v12
    v_add_u32 v13, s35, v13
    s_waitcnt lgkmcnt(0)
    s_barrier
    v_mfma_f32_32x32x16_bf16 v[64:79], v[48:51], v[56:59], v[64:79]
    ds_read_b128 v[32:35], v10 offset:0
    ds_read_b64_tr_b16 v[40:41], v12 offset:0
    ds_read_b64_tr_b16 v[42:43], v12 offset:1024
    v_mfma_f32_32x32x16_bf16 v[80:95], v[52:55], v[56:59], v[80:95]
    ds_read_b128 v[36:39], v11 offset:0
    ds_read_b64_tr_b16 v[44:45], v13 offset:0
    ds_read_b64_tr_b16 v[46:47], v13 offset:1024
    v_mfma_f32_32x32x16_bf16 v[96:111], v[48:51], v[60:63], v[96:111]
    v_lshlrev_b32 v28, 16, v48
    v_and_b32 v29, s38, v48
    v_fmac_f32 v14, v28, v28
    v_fmac_f32 v15, v29, v29
    v_lshlrev_b32 v28, 16, v49
    v_and_b32 v29, s38, v49
    v_fmac_f32 v14, v28, v28
    v_fmac_f32 v15, v29, v29
    v_mfma_f32_32x32x16_bf16 v[112:127], v[52:55], v[60:63], v[112:127]
    v_lshlrev_b32 v28, 16, v50
    v_and_b32 v29, s38, v50
    v_fmac_f32 v14, v28, v28
    v_fmac_f32 v15, v29, v29
    v_lshlrev_b32 v28, 16, v51
    v_and_b32 v29, s38, v51
    v_fmac_f32 v14, v28, v28
    v_fmac_f32 v15, v29, v29
    v_mfma_f32_16x16x32_bf16 v[20:23], v[16:19], v[48:51], v[20:23]
    v_mfma_f32_16x16x32_bf16 v[24:27], v[16:19], v[56:59], v[24:27]
    s_add_u32 s31, s31, 1
    s_cmp_lt_u32 s31, 9
    s_cbranch_scc1 Lk1_loop1
    s_waitcnt vmcnt(0) lgkmcnt(0)
    v_add_f32 v14, v14, v15
    v_mov_b32 v15, v14
    s_lshl_b32 s34, s27, 6
    s_lshl_b32 s35, s28, 5
    s_add_u32 s34, s34, s35
    v_add_u32 v32, s34, v31
    v_lshlrev_b32 v32, 2, v32
    v_add_u32 v32, 132096, v32
    v_permlane32_swap_b32 v14, v15
    s_lshl_b32 s34, s28, 6
    s_lshl_b32 s35, s27, 5
    s_add_u32 s34, s34, s35
    v_and_b32 v33, 31, v1
    v_add_u32 v33, s34, v33
    v_lshlrev_b32 v33, 2, v33
    v_add_u32 v33, 132096, v33
    v_add_f32 v14, v14, v15
    v_mul_f32 v20, 0xbae38e39, v20
    v_mul_f32 v14, 0x3ae38e39, v14
    v_fma_f32 v14, -v20, v20, v14
    v_max_f32 v14, 0, v14
    v_add_f32 v14, 0x3727c5ac, v14
    v_rsq_f32 v14, v14
    ds_write_b32 v32, v20
    ds_write_b32 v33, v24 offset:1024
    ds_write_b32 v32, v14 offset:512
    v_xor_b32 v32, 128, v32
    v_xor_b32 v33, 128, v33
    s_waitcnt lgkmcnt(0)
    s_barrier
    ds_read_b32 v21, v32
    ds_read_b32 v25, v33 offset:1024
    v_lshrrev_b32 v28, 5, v1
    v_lshlrev_b32 v28, 5, v28
    s_lshl_b32 s34, s27, 8
    s_lshl_b32 s35, s28, 7
    s_add_u32 s34, s34, s35
    s_add_u32 s34, s34, 132608
    v_add_u32 v28, s34, v28
    v_xor_b32 v29, 128, v28
    ds_read_b128 v[128:131], v28 offset:0
    ds_read_b128 v[132:135], v28 offset:16
    ds_read_b128 v[136:139], v28 offset:64
    ds_read_b128 v[140:143], v28 offset:80
    ds_read_b128 v[144:147], v29 offset:0
    ds_read_b128 v[148:151], v29 offset:16
    ds_read_b128 v[152:155], v29 offset:64
    ds_read_b128 v[156:159], v29 offset:80
    v_cmp_gt_u32 vcc, 32, v1
    s_nop 1
    v_cndmask_b32 v34, 0, v20, vcc
    v_and_b32 v35, s38, v34
    v_sub_f32 v36, v34, v35
    v_cvt_pk_bf16_f32 v40, v35, v35
    v_cvt_pk_bf16_f32 v41, v36, v36
    v_and_b32 v35, s38, v24
    v_sub_f32 v36, v24, v35
    v_cvt_pk_bf16_f32 v44, v35, v36
    v_cvt_pk_bf16_f32 v45, v35, v36
    s_waitcnt lgkmcnt(8)
    v_cndmask_b32 v34, 0, v21, vcc
    v_and_b32 v35, s38, v34
    v_sub_f32 v36, v34, v35
    v_cvt_pk_bf16_f32 v42, v35, v35
    v_cvt_pk_bf16_f32 v43, v36, v36
    v_and_b32 v35, s38, v25
    v_sub_f32 v36, v25, v35
    v_cvt_pk_bf16_f32 v46, v35, v36
    v_cvt_pk_bf16_f32 v47, v35, v36
    v_mfma_f32_32x32x8_bf16 v[64:79], v[40:41], v[44:45], v[64:79]
    v_mfma_f32_32x32x8_bf16 v[80:95], v[42:43], v[44:45], v[80:95]
    v_mfma_f32_32x32x8_bf16 v[96:111], v[40:41], v[46:47], v[96:111]
    v_mfma_f32_32x32x8_bf16 v[112:127], v[42:43], v[46:47], v[112:127]
    s_add_u32 s20, s8, 0x500000
    s_addc_u32 s21, s9, 0
    s_mov_b32 s22, 0x240000
    s_mov_b32 s23, 0x20000
    s_sub_u32 s34, s26, 9
    s_mul_i32 s40, s34, 126
    s_lshl_b32 s34, s28, 6
    v_bfrev_b32 v161, -2
    s_lshl_b32 s35, s27, 5
    s_add_u32 s34, s34, s35
    v_and_b32 v30, 31, v1
    v_add_u32 v30, s34, v30
    v_lshrrev_b32 v34, 5, v1
    v_mul_u32_u24 v34, 288, v34
    s_mov_b32 s35, 73440
    v_add_u32 v160, s40, v30
    v_cmp_gt_u32 vcc, 126, v30
    v_mul_u32_u24 v35, 3641, v160
    v_lshrrev_b32 v35, 16, v35
    v_mul_lo_u32 v35, v35, s35
    v_lshl_add_u32 v35, v160, 4, v35
    v_add_u32 v35, v35, v34
    v_cndmask_b32 v28, v161, v35, vcc
    v_xor_b32 v30, 32, v30
    v_add_u32 v160, s40, v30
    v_cmp_gt_u32 vcc, 126, v30
    v_mul_u32_u24 v35, 3641, v160
    v_lshrrev_b32 v35, 16, v35
    v_mul_lo_u32 v35, v35, s35
    v_lshl_add_u32 v35, v160, 4, v35
    v_add_u32 v35, v35, v34
    v_cndmask_b32 v29, v161, v35, vcc
    s_lshl_b32 s34, s25, 2
    s_lshl_b32 s35, s27, 1
    s_add_u32 s34, s34, s35
    s_add_u32 s34, s34, s28
    s_mul_i32 s40, s34, 1152
    s_xor_b32 s34, s34, 1
    s_mul_i32 s41, s34, 1152
    s_waitcnt lgkmcnt(0)
    v_pk_mul_f32 v[64:65], v[64:65], v[128:129]
    v_pk_mul_f32 v[66:67], v[66:67], v[130:131]
    v_pk_mul_f32 v[68:69], v[68:69], v[132:133]
    v_pk_mul_f32 v[70:71], v[70:71], v[134:135]
    v_cvt_pk_bf16_f32 v64, v64, v65
    v_cvt_pk_bf16_f32 v65, v66, v67
    v_cvt_pk_bf16_f32 v66, v68, v69
    v_cvt_pk_bf16_f32 v67, v70, v71
    buffer_store_dwordx4 v[64:67], v28, s[20:23], s40 offen offset:0 sc1
    v_pk_mul_f32 v[72:73], v[72:73], v[136:137]
    v_pk_mul_f32 v[74:75], v[74:75], v[138:139]
    v_pk_mul_f32 v[76:77], v[76:77], v[140:141]
    v_pk_mul_f32 v[78:79], v[78:79], v[142:143]
    v_cvt_pk_bf16_f32 v72, v72, v73
    v_cvt_pk_bf16_f32 v73, v74, v75
    v_cvt_pk_bf16_f32 v74, v76, v77
    v_cvt_pk_bf16_f32 v75, v78, v79
    buffer_store_dwordx4 v[72:75], v28, s[20:23], s40 offen offset:576 sc1
    v_pk_mul_f32 v[80:81], v[80:81], v[144:145]
    v_pk_mul_f32 v[82:83], v[82:83], v[146:147]
    v_pk_mul_f32 v[84:85], v[84:85], v[148:149]
    v_pk_mul_f32 v[86:87], v[86:87], v[150:151]
    v_cvt_pk_bf16_f32 v80, v80, v81
    v_cvt_pk_bf16_f32 v81, v82, v83
    v_cvt_pk_bf16_f32 v82, v84, v85
    v_cvt_pk_bf16_f32 v83, v86, v87
    buffer_store_dwordx4 v[80:83], v28, s[20:23], s41 offen offset:0 sc1
    v_pk_mul_f32 v[88:89], v[88:89], v[152:153]
    v_pk_mul_f32 v[90:91], v[90:91], v[154:155]
    v_pk_mul_f32 v[92:93], v[92:93], v[156:157]
    v_pk_mul_f32 v[94:95], v[94:95], v[158:159]
    v_cvt_pk_bf16_f32 v88, v88, v89
    v_cvt_pk_bf16_f32 v89, v90, v91
    v_cvt_pk_bf16_f32 v90, v92, v93
    v_cvt_pk_bf16_f32 v91, v94, v95
    buffer_store_dwordx4 v[88:91], v28, s[20:23], s41 offen offset:576 sc1
    v_pk_mul_f32 v[96:97], v[96:97], v[128:129]
    v_pk_mul_f32 v[98:99], v[98:99], v[130:131]
    v_pk_mul_f32 v[100:101], v[100:101], v[132:133]
    v_pk_mul_f32 v[102:103], v[102:103], v[134:135]
    v_cvt_pk_bf16_f32 v96, v96, v97
    v_cvt_pk_bf16_f32 v97, v98, v99
    v_cvt_pk_bf16_f32 v98, v100, v101
    v_cvt_pk_bf16_f32 v99, v102, v103
    buffer_store_dwordx4 v[96:99], v29, s[20:23], s40 offen offset:0 sc1
    v_pk_mul_f32 v[104:105], v[104:105], v[136:137]
    v_pk_mul_f32 v[106:107], v[106:107], v[138:139]
    v_pk_mul_f32 v[108:109], v[108:109], v[140:141]
    v_pk_mul_f32 v[110:111], v[110:111], v[142:143]
    v_cvt_pk_bf16_f32 v104, v104, v105
    v_cvt_pk_bf16_f32 v105, v106, v107
    v_cvt_pk_bf16_f32 v106, v108, v109
    v_cvt_pk_bf16_f32 v107, v110, v111
    buffer_store_dwordx4 v[104:107], v29, s[20:23], s40 offen offset:576 sc1
    v_pk_mul_f32 v[112:113], v[112:113], v[144:145]
    v_pk_mul_f32 v[114:115], v[114:115], v[146:147]
    v_pk_mul_f32 v[116:117], v[116:117], v[148:149]
    v_pk_mul_f32 v[118:119], v[118:119], v[150:151]
    v_cvt_pk_bf16_f32 v112, v112, v113
    v_cvt_pk_bf16_f32 v113, v114, v115
    v_cvt_pk_bf16_f32 v114, v116, v117
    v_cvt_pk_bf16_f32 v115, v118, v119
    buffer_store_dwordx4 v[112:115], v29, s[20:23], s41 offen offset:0 sc1
    v_pk_mul_f32 v[120:121], v[120:121], v[152:153]
    v_pk_mul_f32 v[122:123], v[122:123], v[154:155]
    v_pk_mul_f32 v[124:125], v[124:125], v[156:157]
    v_pk_mul_f32 v[126:127], v[126:127], v[158:159]
    v_cvt_pk_bf16_f32 v120, v120, v121
    v_cvt_pk_bf16_f32 v121, v122, v123
    v_cvt_pk_bf16_f32 v122, v124, v125
    v_cvt_pk_bf16_f32 v123, v126, v127
    buffer_store_dwordx4 v[120:123], v29, s[20:23], s41 offen offset:576 sc1
Lk1_end:
    s_branch Ljoin
Lk1_aux:
    s_cmp_ge_u32 s2, 256
    s_cbranch_scc1 Lend
    s_getpc_b64 s[10:11]
Lcp7:
    s_sub_u32 s10, s10, Lcp7-Lk1_cw
    s_subb_u32 s11, s11, 0
    v_lshlrev_b32 v164, 7, v0
    v_min_u32 v164, Lcode_end-Lk1_cw, v164
    v_mov_b32 v165, 0
    v_lshl_add_u64 v[164:165], v[164:165], 0, s[10:11]
    global_load_dword v166, v[164:165], off
    s_load_dwordx2 s[8:9], s[0:1], 80
    s_load_dwordx2 s[50:51], s[0:1], 16
    v_lshrrev_b32 v2, 6, v0
    v_and_b32 v1, 63, v0
    v_readfirstlane_b32 s24, v2
    s_sub_u32 s62, s2, 224
    s_lshl_b32 s63, s24, 5
    s_add_u32 s62, s62, s63
    v_and_b32 v5, 15, v1
    v_lshrrev_b32 v7, 4, v1
    s_waitcnt lgkmcnt(0)
    s_mov_b32 s12, s8
    s_mov_b32 s13, s9
    s_mov_b32 s14, 0x3448400
    s_mov_b32 s15, 0x20000
    s_mov_b32 s64, s50
    s_mov_b32 s65, s51
    s_mov_b32 s66, 0xa2000
    s_mov_b32 s67, 0x20000
    s_cmp_ge_u32 s62, 81
    s_cbranch_scc0 Lk1_wo
    s_sub_u32 s62, s62, 81
    s_mul_i32 s62, s62, 2048
    s_add_u32 s62, s62, 54525952
    v_lshl_add_u32 v6, v1, 4, s62
    v_mov_b32 v8, 0
    v_mov_b32 v9, 0
    v_mov_b32 v10, 0
    v_mov_b32 v11, 0
    buffer_store_dwordx4 v[8:11], v6, s[12:15], 0 offen offset:0 sc1
    buffer_store_dwordx4 v[8:11], v6, s[12:15], 0 offen offset:1024 sc1
    s_branch Laux2
Lk1_wo:
    s_mul_i32 s63, s62, 57
    s_lshr_b32 s63, s63, 9
    s_mul_i32 s80, s63, 9
    s_sub_u32 s62, s62, s80
    s_mov_b32 s73, 1024
    s_mul_i32 s76, s62, 73728
    s_lshl_b32 s80, s63, 11
    s_add_u32 s76, s76, s80
    s_add_u32 s76, s76, 11534336
    s_add_u32 s77, s76, 16
    s_add_u32 s78, s76, 32
    s_add_u32 s79, s76, 48
    v_lshrrev_b32 v6, 2, v5
    v_mul_u32_u24 v6, 18432, v6
    v_lshl_add_u32 v6, v7, 8, v6
    v_and_b32 v8, 3, v1
    v_lshl_add_u32 v6, v8, 6, v6
    s_lshl_b32 s72, s62, 7
    s_mov_b32 s71, 1152
    s_mul_i32 s80, s63, 82944
    s_mov_b32 s68, 41472
    s_mov_b32 s69, 9216
    s_mov_b32 s70, 2304
    s_mov_b32 s74, 20736
    s_mov_b32 s75, 4608
    s_cmp_eq_u32 s63, 8
    s_cbranch_scc0 Lk1_com
    s_mov_b32 s80, 18432
    s_mov_b32 s68, 331776
    s_mov_b32 s69, 165888
    s_mov_b32 s70, 82944
    s_mov_b32 s74, 41472
    s_mov_b32 s75, 20736
Lk1_com:
    s_add_u32 s72, s72, s80
    v_lshlrev_b32 v5, 3, v5
    v_lshrrev_b32 v8, 1, v7
    v_and_b32 v7, 1, v7
    v_mad_u32_u24 v5, v8, s74, v5
    v_mad_u32_u24 v5, v7, s75, v5
    s_mov_b32 s82, 0x05040100
    s_mov_b32 s83, 0x07060302
    buffer_load_dwordx2 v[32:33], v5, s[64:67], s72 offen
    s_add_u32 s80, s72, s71
    buffer_load_dwordx2 v[34:35], v5, s[64:67], s80 offen
    s_add_u32 s80, s72, s70
    buffer_load_dwordx2 v[36:37], v5, s[64:67], s80 offen
    s_add_u32 s80, s72, s70
    s_add_u32 s80, s80, s71
    buffer_load_dwordx2 v[38:39], v5, s[64:67], s80 offen
    s_add_u32 s80, s72, s69
    buffer_load_dwordx2 v[40:41], v5, s[64:67], s80 offen
    s_add_u32 s80, s72, s69
    s_add_u32 s80, s80, s71
    buffer_load_dwordx2 v[42:43], v5, s[64:67], s80 offen
    s_add_u32 s80, s72, s69
    s_add_u32 s80, s80, s70
    buffer_load_dwordx2 v[44:45], v5, s[64:67], s80 offen
    s_add_u32 s80, s72, s69
    s_add_u32 s80, s80, s70
    s_add_u32 s80, s80, s71
    buffer_load_dwordx2 v[46:47], v5, s[64:67], s80 offen
    s_add_u32 s80, s72, s68
    buffer_load_dwordx2 v[48:49], v5, s[64:67], s80 offen
    s_add_u32 s80, s72, s68
    s_add_u32 s80, s80, s71
    buffer_load_dwordx2 v[50:51], v5, s[64:67], s80 offen
    s_add_u32 s80, s72, s68
    s_add_u32 s80, s80, s70
    buffer_load_dwordx2 v[52:53], v5, s[64:67], s80 offen
    s_add_u32 s80, s72, s68
    s_add_u32 s80, s80, s70
    s_add_u32 s80, s80, s71
    buffer_load_dwordx2 v[54:55], v5, s[64:67], s80 offen
    s_add_u32 s80, s72, s68
    s_add_u32 s80, s80, s69
    buffer_load_dwordx2 v[56:57], v5, s[64:67], s80 offen
    s_add_u32 s80, s72, s68
    s_add_u32 s80, s80, s69
    s_add_u32 s80, s80, s71
    buffer_load_dwordx2 v[58:59], v5, s[64:67], s80 offen
    s_add_u32 s80, s72, s68
    s_add_u32 s80, s80, s69
    s_add_u32 s80, s80, s70
    buffer_load_dwordx2 v[60:61], v5, s[64:67], s80 offen
    s_add_u32 s80, s72, s68
    s_add_u32 s80, s80, s69
    s_add_u32 s80, s80, s70
    s_add_u32 s80, s80, s71
    buffer_load_dwordx2 v[62:63], v5, s[64:67], s80 offen
    s_waitcnt vmcnt(0)
    v_perm_b32 v64, v34, v32, s82
    v_perm_b32 v65, v38, v36, s82
    v_perm_b32 v66, v42, v40, s82
    v_perm_b32 v67, v46, v44, s82
    buffer_store_dwordx4 v[64:67], v6, s[12:15], s76 offen sc1
    v_perm_b32 v68, v34, v32, s83
    v_perm_b32 v69, v38, v36, s83
    v_perm_b32 v70, v42, v40, s83
    v_perm_b32 v71, v46, v44, s83
    buffer_store_dwordx4 v[68:71], v6, s[12:15], s77 offen sc1
    v_perm_b32 v72, v35, v33, s82
    v_perm_b32 v73, v39, v37, s82
    v_perm_b32 v74, v43, v41, s82
    v_perm_b32 v75, v47, v45, s82
    buffer_store_dwordx4 v[72:75], v6, s[12:15], s78 offen sc1
    v_perm_b32 v76, v35, v33, s83
    v_perm_b32 v77, v39, v37, s83
    v_perm_b32 v78, v43, v41, s83
    v_perm_b32 v79, v47, v45, s83
    buffer_store_dwordx4 v[76:79], v6, s[12:15], s79 offen sc1
    v_perm_b32 v80, v50, v48, s82
    v_perm_b32 v81, v54, v52, s82
    v_perm_b32 v82, v58, v56, s82
    v_perm_b32 v83, v62, v60, s82
    s_add_u32 s76, s76, s73
    buffer_store_dwordx4 v[80:83], v6, s[12:15], s76 offen sc1
    v_perm_b32 v84, v50, v48, s83
    v_perm_b32 v85, v54, v52, s83
    v_perm_b32 v86, v58, v56, s83
    v_perm_b32 v87, v62, v60, s83
    s_add_u32 s77, s77, s73
    buffer_store_dwordx4 v[84:87], v6, s[12:15], s77 offen sc1
    v_perm_b32 v88, v51, v49, s82
    v_perm_b32 v89, v55, v53, s82
    v_perm_b32 v90, v59, v57, s82
    v_perm_b32 v91, v63, v61, s82
    s_add_u32 s78, s78, s73
    buffer_store_dwordx4 v[88:91], v6, s[12:15], s78 offen sc1
    v_perm_b32 v92, v51, v49, s83
    v_perm_b32 v93, v55, v53, s83
    v_perm_b32 v94, v59, v57, s83
    v_perm_b32 v95, v63, v61, s83
    s_add_u32 s79, s79, s73
    buffer_store_dwordx4 v[92:95], v6, s[12:15], s79 offen sc1
Laux2:
    s_load_dwordx2 s[10:11], s[0:1], 72
    s_waitcnt lgkmcnt(0)
    s_mov_b32 s20, s10
    s_mov_b32 s21, s11
    s_mov_b32 s22, 0x100
    s_mov_b32 s23, 0x20000
    s_sub_u32 s62, s2, 224
    s_lshl_b32 s62, s62, 2
    s_mov_b32 s61, 0xf0
    s_waitcnt vmcnt(0)
    s_barrier
    s_cmp_eq_u32 s24, 4
    s_cbranch_scc0 Laux3
    s_mov_b64 exec, 1
    v_mov_b32 v3, 1
    buffer_store_dword v3, off, s[20:23], s62 sc1
    s_mov_b64 exec, -1
Laux3:
    v_and_b32 v30, 31, v1
    v_lshlrev_b32 v30, 2, v30
    v_mov_b32 v31, 1
    s_cmp_eq_u32 s24, 4
    s_cbranch_scc0 Ljoin
    buffer_load_dword v31, v30, s[20:23], 0 offen sc1
Ljoin:
    s_cmp_ge_u32 s2, 256
    s_cbranch_scc1 Lend
    s_load_dwordx2 s[8:9], s[0:1], 80
    s_load_dwordx2 s[4:5], s[0:1], 0
    s_load_dwordx4 s[64:67], s[0:1], 32
    s_load_dwordx2 s[54:55], s[0:1], 48
    v_lshrrev_b32 v2, 6, v0
    v_and_b32 v1, 63, v0
    v_readfirstlane_b32 s24, v2
    s_and_b32 s3, s2, 7
    s_lshr_b32 s59, s2, 3
    s_and_b32 s25, s59, 3
    s_lshl_b32 s27, s3, 2
    s_add_u32 s25, s25, s27
    s_lshr_b32 s26, s59, 2
    s_mul_i32 s27, s25, 9
    s_lshr_b32 s27, s27, 1
    v_lshl_add_u32 v8, v1, 3, v2
    v_mul_u32_u24 v9, 3450, v8
    v_lshrrev_b32 v9, 16, v9
    v_mul_u32_u24 v10, 19, v9
    v_sub_u32 v10, v8, v10
    v_add_u32 v9, s26, v9
    v_and_b32 v9, 7, v9
    v_and_b32 v11, 1, v10
    v_lshrrev_b32 v12, 2, v10
    v_lshl_add_u32 v12, v11, 1, v12
    v_bfe_u32 v13, v10, 1, 1
    v_cmp_lt_u32 vcc, 7, v10
    s_add_u32 s28, s27, 144
    s_lshl_b32 s28, s28, 14
    v_cndmask_b32 v12, v12, 4, vcc
    v_cndmask_b32 v13, v13, v11, vcc
    v_lshlrev_b32 v12, 14, v12
    v_lshl_add_u32 v12, v13, 10, v12
    v_lshl_add_u32 v12, v9, 11, v12
    v_add_u32 v12, s28, v12
    s_mul_i32 s28, s25, 73728
    s_add_u32 s28, s28, 5232640
    v_mul_u32_u24 v13, 9216, v9
    v_lshl_add_u32 v13, v10, 10, v13
    v_add_u32 v13, s28, v13
    v_cmp_lt_u32 vcc, 9, v10
    v_lshlrev_b32 v7, 4, v1
    s_lshl_b32 s29, s24, 10
    s_mov_b32 m0, s29
    v_cndmask_b32 v12, v12, v13, vcc
    v_lshrrev_b32 v3, 5, v1
    v_and_b32 v2, 31, v1
    s_lshl_b32 s28, s26, 3
    s_add_u32 s28, s28, s24
    s_lshl_b32 s56, s28, 8
    s_lshl_b32 s27, s27, 14
    s_add_u32 s56, s56, s27
    s_add_u32 s57, s56, 16384
    s_add_u32 s58, s56, 65536
    v_readlane_b32 s30, v12, 0
    v_readlane_b32 s31, v12, 1
    v_readlane_b32 s32, v12, 2
    v_readlane_b32 s33, v12, 3
    v_readlane_b32 s34, v12, 4
    v_lshlrev_b32 v15, 3, v2
    v_lshl_add_u32 v4, v3, 15, v15
    v_mov_b32 v14, v12
    s_mov_b32 s60, 0
    s_waitcnt lgkmcnt(0)
    s_mov_b64 s[6:7], s[66:67]
    s_mov_b32 s66, 5308416
    s_mov_b32 s67, 0x20000
    s_mov_b32 s12, s8
    s_mov_b32 s13, s9
    s_mov_b32 s14, 0x4000000
    s_mov_b32 s15, 0x20000
    v_mov_b32 v19, -1
    v_mov_b32 v22, -1
    v_mov_b32 v23, -1
    s_cmp_lt_u32 s24, 4
    s_cbranch_scc1 Lj7
    s_cmp_ge_u32 s2, 224
    s_cbranch_scc1 Lj7
    s_barrier
    s_barrier
Lj7:
    s_xor_b32 s63, s24, 0
    s_lshl_b32 s63, s63, 5
    s_add_u32 s62, s59, s63
    s_cmp_ge_u32 s62, 162
    s_cbranch_scc1 Lsh_skip
    v_and_b32 v5, 15, v1
    v_lshrrev_b32 v145, 4, v1
    s_cmp_ge_u32 s62, 81
    s_cselect_b32 s63, 81, 0
    s_cselect_b32 s82, 1, 0
    s_sub_u32 s62, s62, s63
    s_mul_i32 s63, s62, 57
    s_lshr_b32 s63, s63, 9
    s_mul_i32 s80, s63, 9
    s_sub_u32 s62, s62, s80
    s_mov_b32 s73, 3072
    s_mul_i32 s80, s3, 1327104
    s_mul_i32 s81, s63, 6144
    s_add_u32 s80, s80, s81
    s_add_u32 s80, s80, 16777216
    s_lshl_b32 s81, s62, 2
    s_lshl_b32 s72, s62, 7
    s_cmp_eq_u32 s82, 1
    s_cbranch_scc1 Lsh_w2
    s_mul_i32 s83, s62, 11
    s_lshr_b32 s83, s83, 5
    s_mul_i32 s83, s83, 218112
    s_lshl_b32 s84, s62, 10
    s_add_u32 s83, s83, s84
    s_add_u32 s76, s83, s80
    s_add_u32 s77, s76, 55296
    s_add_u32 s78, s77, 55296
    s_add_u32 s79, s78, 55296
    v_mov_b32 v6, v7
    s_mov_b32 s68, 294912
    s_mov_b32 s69, 36864
    s_mov_b32 s70, 18432
    s_mov_b32 s71, 9216
    s_mov_b32 s74, 147456
    s_mov_b32 s75, 73728
    s_mul_i32 s80, s63, 589824
    s_mul_i32 s81, s3, 1152
    s_branch Lsh_com
Lsh_w2:
    s_add_u32 s80, s80, 663552
    s_mul_i32 s83, s81, 57
    s_lshr_b32 s83, s83, 9
    s_mul_i32 s84, s83, 9
    s_sub_u32 s84, s81, s84
    s_mul_i32 s83, s83, 55296
    s_add_u32 s76, s83, s80
    s_lshl_b32 s83, s84, 10
    s_add_u32 s76, s76, s83
    s_mul_i32 s84, s84, 11
    s_lshr_b32 s84, s84, 5
    s_mul_i32 s84, s84, 218112
    s_add_u32 s76, s76, s84
    s_add_u32 s81, s81, 1
    s_mul_i32 s83, s81, 57
    s_lshr_b32 s83, s83, 9
    s_mul_i32 s84, s83, 9
    s_sub_u32 s84, s81, s84
    s_mul_i32 s83, s83, 55296
    s_add_u32 s77, s83, s80
    s_lshl_b32 s83, s84, 10
    s_add_u32 s77, s77, s83
    s_mul_i32 s84, s84, 11
    s_lshr_b32 s84, s84, 5
    s_mul_i32 s84, s84, 218112
    s_add_u32 s77, s77, s84
    s_add_u32 s81, s81, 1
    s_mul_i32 s83, s81, 57
    s_lshr_b32 s83, s83, 9
    s_mul_i32 s84, s83, 9
    s_sub_u32 s84, s81, s84
    s_mul_i32 s83, s83, 55296
    s_add_u32 s78, s83, s80
    s_lshl_b32 s83, s84, 10
    s_add_u32 s78, s78, s83
    s_mul_i32 s84, s84, 11
    s_lshr_b32 s84, s84, 5
    s_mul_i32 s84, s84, 218112
    s_add_u32 s78, s78, s84
    s_add_u32 s81, s81, 1
    s_mul_i32 s83, s81, 57
    s_lshr_b32 s83, s83, 9
    s_mul_i32 s84, s83, 9
    s_sub_u32 s84, s81, s84
    s_mul_i32 s83, s83, 55296
    s_add_u32 s79, s83, s80
    s_lshl_b32 s83, s84, 10
    s_add_u32 s79, s79, s83
    s_mul_i32 s84, s84, 11
    s_lshr_b32 s84, s84, 5
    s_mul_i32 s84, s84, 218112
    s_add_u32 s79, s79, s84
    v_and_b32 v5, 3, v1
    v_lshl_add_u32 v5, v145, 2, v5
    v_bfe_u32 v145, v1, 2, 2
    v_lshlrev_b32 v6, 4, v5
    v_lshl_add_u32 v6, v145, 8, v6
    s_mov_b32 s64, s54
    s_mov_b32 s65, s55
    s_mov_b32 s68, 2304
    s_mov_b32 s69, 1152
    s_mov_b32 s70, 9216
    s_mov_b32 s71, 4608
    s_mov_b32 s74, 36864
    s_mov_b32 s75, 18432
    s_mul_i32 s80, s63, 73728
    s_mul_i32 s81, s3, 663552
Lsh_com:
    s_add_u32 s72, s72, s80
    s_add_u32 s72, s72, s81
    v_lshlrev_b32 v5, 3, v5
    v_lshrrev_b32 v144, 1, v145
    v_and_b32 v145, 1, v145
    v_mad_u32_u24 v5, v144, s74, v5
    v_mad_u32_u24 v5, v145, s75, v5
    s_add_u32 s60, s82, 1
    s_mov_b32 s82, 0x05040100
    s_mov_b32 s83, 0x07060302
Lsh_skip:
    s_cmp_ge_u32 s24, 4
    s_cbranch_scc1 Lj0
    s_cmp_eq_u32 s24, 3
    s_cbranch_scc0 Lj9
    s_lshr_b32 s62, s27, 12
    s_mul_i32 s63, s25, 18
    s_mul_i32 s16, s25, 37
    s_lshr_b32 s16, s16, 8
    s_lshl1_add_u32 s63, s16, s63
    s_lshl_b32 s16, s26, 1
    v_subrev_u32 v16, s16, v1
    v_and_b32 v16, 15, v16
    v_cmp_gt_u32 s[16:17], 4, v16
    v_lshrrev_b32 v16, 4, v1
    v_and_b32 v17, 1, v16
    v_mul_u32_u24 v18, 19, v17
    v_mul_u32_u24 v19, 17, v17
    v_add_u32 v18, s62, v18
    v_add_u32 v19, s63, v19
    v_add_u32 v20, 576, v18
    v_add_u32 v19, 1152, v19
    v_cmp_lt_u32 vcc, 1, v16
    v_bfe_u32 v18, v18, 7, 1
    v_and_b32 v21, 15, v1
    v_cndmask_b32 v19, v20, v19, vcc
    v_bfe_u32 v19, v19, 7, 1
    v_lshl_add_u32 v19, v19, 4, v21
    v_lshrrev_b32 v16, 1, v16
    v_lshl_add_u32 v19, v16, 6, v19
    v_lshlrev_b32 v19, 1, v19
    v_and_b32 v21, 1, v1
    v_lshl_add_u32 v18, v18, 1, v21
    v_lshlrev_b32 v18, 1, v18
    s_lshl_b32 s62, s25, 3
    s_add_u32 s62, s62, s26
    s_lshl_b32 s62, s62, 8
    s_add_u32 s62, s62, 54559744
    s_mov_b32 s84, 0x4000
    s_waitcnt vmcnt(0)
    s_barrier
Lj1:
    buffer_load_ushort v24, v19, s[12:15], s62 offen sc1
    buffer_load_ushort v25, v18, s[12:15], s62 offen offset:64 sc1
    s_waitcnt vmcnt(0)
    v_and_b32 v20, v24, v25
    v_cmp_ne_u32 vcc, 1, v20
    s_nop 0
    s_and_b64 s[18:19], vcc, s[16:17]
    s_cbranch_scc0 Lj3
    s_sub_u32 s84, s84, 1
    s_cbranch_scc0 Lj1
Lj3:
    s_branch Lj2
Lj0:
    s_lshr_b32 s62, s61, 4
    s_and_b32 s63, s61, 15
    v_subrev_u32 v16, 256, v0
    v_lshrrev_b32 v17, 3, v16
    v_lshlrev_b32 v16, 8, v16
    v_add_u32 v16, 54559744, v16
    v_mul_u32_u24 v18, 18, v17
    v_and_b32 v19, -4, v18
    s_cmp_ge_u32 s62, 9
    s_cselect_b64 vcc, -1, 0
    s_cselect_b32 s16, 17, 19
    s_cselect_b32 s17, 128, 0
    v_add_u32 v20, 576, v19
    v_mul_u32_u24 v17, 37, v17
    v_lshrrev_b32 v17, 8, v17
    v_lshl_add_u32 v18, v17, 1, v18
    v_add_u32 v18, 1152, v18
    v_cndmask_b32 v20, v20, v18, vcc
    v_add_u32 v21, s16, v20
    v_lshrrev_b32 v20, 7, v20
    v_lshrrev_b32 v21, 7, v21
    v_cmp_eq_u32 vcc, s62, v20
    v_cmp_eq_u32 s[18:19], s62, v21
    s_and_b32 s16, s62, 1
    s_lshl_b32 s49, s16, 5
    s_add_u32 s17, s17, s49
    s_lshl_b32 s49, s63, 1
    s_add_u32 s17, s17, s49
    s_or_b64 vcc, vcc, s[18:19]
    v_add_u32 v22, s17, v16
    v_bfrev_b32 v24, -2
    v_cndmask_b32 v22, v24, v22, vcc
    v_add_u32 v21, 19, v19
    v_lshrrev_b32 v20, 7, v19
    v_lshrrev_b32 v21, 7, v21
    v_cmp_eq_u32 vcc, s62, v20
    v_cmp_eq_u32 s[18:19], s62, v21
    v_and_b32 v20, 7, v1
    s_lshr_b32 s17, s63, 1
    s_or_b64 vcc, vcc, s[18:19]
    v_cmp_eq_u32 s[18:19], s17, v20
    s_lshl_b32 s16, s16, 2
    s_and_b32 s49, s49, 2
    s_add_u32 s16, s16, s49
    s_add_u32 s16, s16, 64
    s_and_b64 vcc, vcc, s[18:19]
    v_add_u32 v23, s16, v16
    v_cndmask_b32 v23, v24, v23, vcc
    v_mov_b32 v16, 1
    s_mov_b32 s84, 0x4000
    s_waitcnt vmcnt(0)
Lj8:
    v_cmp_ne_u32 vcc, 1, v31
    s_cbranch_vccz Lj9
    buffer_load_dword v31, v30, s[20:23], 0 offen sc1
    s_waitcnt vmcnt(0)
    s_sub_u32 s84, s84, 1
    s_cbranch_scc0 Lj8
Lj9:
    s_cmp_ge_u32 s24, 4
    s_waitcnt vmcnt(0)
    s_barrier
    s_cbranch_scc0 Lj5
    buffer_store_short v16, v22, s[12:15], 0 offen sc1
    buffer_store_short v16, v23, s[12:15], 0 offen sc1
Lj5:
Lj2:
    s_barrier
    buffer_load_dwordx4 v7, s[12:15], s30 offen lds
    s_add_u32 m0, m0, 0x2000
    s_nop 0
    buffer_load_dwordx4 v7, s[12:15], s31 offen lds
    s_add_u32 m0, m0, 0x2000
    s_nop 0
    buffer_load_dwordx4 v7, s[12:15], s32 offen lds
    s_add_u32 m0, m0, 0x2000
    buffer_load_dwordx2 v[8:9], v4, s[12:15], s56 offen
    buffer_load_dwordx2 v[10:11], v4, s[12:15], s57 offen
    buffer_load_dwordx2 v[12:13], v15, s[12:15], s58 offen
    v_readlane_b32 s35, v14, 5
    v_readlane_b32 s36, v14, 6
    v_readlane_b32 s37, v14, 7
    v_readlane_b32 s38, v14, 8
    v_readlane_b32 s39, v14, 9
    v_readlane_b32 s40, v14, 10
    v_readlane_b32 s41, v14, 11
    v_readlane_b32 s42, v14, 12
    v_readlane_b32 s43, v14, 13
    v_readlane_b32 s44, v14, 14
    v_readlane_b32 s45, v14, 15
    v_readlane_b32 s46, v14, 16
    v_readlane_b32 s47, v14, 17
    v_readlane_b32 s48, v14, 18
    v_mov_b32 v128, 0
    v_mov_b32 v129, 0
    v_mov_b32 v130, 0
    v_mov_b32 v131, 0
    v_mov_b32 v132, 0
    v_mov_b32 v133, 0
    v_mov_b32 v134, 0
    v_mov_b32 v135, 0
    v_mov_b32 v136, 0
    v_mov_b32 v137, 0
    v_mov_b32 v138, 0
    v_mov_b32 v139, 0
    v_mov_b32 v140, 0
    v_mov_b32 v141, 0
    v_mov_b32 v142, 0
    v_mov_b32 v143, 0
    v_mov_b32 v32, 0x3f803f80
    v_mov_b32 v33, 0x3f803f80
    v_mov_b32 v34, 0x3f803f80
    v_mov_b32 v35, 0x3f803f80
    v_mov_b32 v36, 0x3f803f80
    v_mov_b32 v37, 0x3f803f80
    v_mov_b32 v38, 0x3f803f80
    v_mov_b32 v39, 0x3f803f80
    v_mov_b32 v40, 0x3f803f80
    v_mov_b32 v41, 0x3f803f80
    v_mov_b32 v42, 0x3f803f80
    v_mov_b32 v43, 0x3f803f80
    v_mov_b32 v44, 0x3f803f80
    v_mov_b32 v45, 0x3f803f80
    v_mov_b32 v46, 0x3f803f80
    v_mov_b32 v47, 0x3f803f80
    s_and_b32 s50, s59, 3
    s_lshl_b32 s51, s26, 3
    s_add_u32 s51, s51, s3
    s_lshr_b32 s52, s51, 1
    s_and_b32 s53, s51, 1
    v_mov_b32 v4, 0xdddd
    s_mov_b32 s20, 0x3ffff
    s_mov_b32 s21, 0x3ffff
    s_mov_b32 s22, 0
    s_mov_b32 s23, 8
    s_and_b32 s27, s25, 1
    s_cmp_eq_u32 s27, 1
    s_cselect_b32 s18, -1, 0
    s_mov_b32 s19, 0
    s_cselect_b64 s[16:17], -1, 0
    s_cmp_eq_u32 s24, 3
    s_cbranch_scc0 Ljb
    s_mov_b32 s84, 0x4000
Lja:
    v_cmp_ne_u32 vcc, 1, v20
    s_cbranch_vccz Ljb
    buffer_load_ushort v20, v19, s[12:15], s62 offen sc1
    s_waitcnt vmcnt(0)
    s_sub_u32 s84, s84, 1
    s_cbranch_scc0 Lja
Ljb:
    v_cmp_gt_u32 vcc, 32, v1
    s_waitcnt vmcnt(0)
    v_cndmask_b32 v8, v8, 0, s[18:19]
    v_cndmask_b32 v13, 0, v13, s[16:17]
    v_cndmask_b32 v14, v12, 0, vcc
    v_cndmask_b32 v12, 0, v12, vcc
    v_cndmask_b32 v15, v13, 0, vcc
    v_cndmask_b32 v13, 0, v13, vcc
    s_mov_b32 s16, s4
    s_mov_b32 s17, s5
    s_mov_b32 s18, 2359296
    s_mov_b32 s19, 0x20000
    s_barrier
    buffer_load_dwordx4 v7, s[12:15], s33 offen lds
    s_add_u32 m0, m0, 0x2000
    s_nop 0
    buffer_load_dwordx4 v7, s[12:15], s34 offen lds
    s_add_u32 m0, m0, 0x2000
Lrestart:
    v_lshrrev_b32 v3, 5, v1
    v_and_b32 v2, 31, v1
    v_lshlrev_b32 v16, 4, v2
    v_lshlrev_b32 v2, 3, v2
    v_lshl_add_u32 v2, v3, 10, v2
    v_mul_u32_u24 v3, 288, v3
    v_add_u32 v3, v3, v16
    ds_read_b64 v[16:17], v2 offset:0
    ds_read_b64 v[18:19], v2 offset:4096
    ds_read_b64 v[24:25], v2 offset:8192
    ds_read_b64 v[20:21], v2 offset:256
    ds_read_b64 v[22:23], v2 offset:4352
    ds_read_b64 v[26:27], v2 offset:8448
    v_mov_b32 v48, 0
    v_mov_b32 v49, 0
    v_mov_b32 v50, 0
    v_mov_b32 v51, 0
    v_mov_b32 v52, 0
    v_mov_b32 v53, 0
    v_mov_b32 v54, 0
    v_mov_b32 v55, 0
    v_mov_b32 v56, 0
    v_mov_b32 v57, 0
    v_mov_b32 v58, 0
    v_mov_b32 v59, 0
    v_mov_b32 v60, 0
    v_mov_b32 v61, 0
    v_mov_b32 v62, 0
    v_mov_b32 v63, 0
    v_mov_b32 v112, 0
    v_mov_b32 v113, 0
    v_mov_b32 v114, 0
    v_mov_b32 v115, 0
    v_mov_b32 v116, 0
    v_mov_b32 v117, 0
    v_mov_b32 v118, 0
    v_mov_b32 v119, 0
    v_mov_b32 v120, 0
    v_mov_b32 v121, 0
    v_mov_b32 v122, 0
    v_mov_b32 v123, 0
    v_mov_b32 v124, 0
    v_mov_b32 v125, 0
    v_mov_b32 v126, 0
    v_mov_b32 v127, 0
    s_cmp_lt_u32 s24, 4
    s_cselect_b64 vcc, -1, 0
    s_setprio 1
    s_waitcnt lgkmcnt(3)
    v_mfma_f32_32x32x16_bf16 v[64:79], v[16:19], v[8:11], v[128:143]
    v_mfma_f32_32x32x8_bf16 v[64:79], v[24:25], v[12:13], v[64:79]
    s_nop 9
    s_cmp_lt_u32 s22, 8
    s_cbranch_scc0 Lloop
    s_getpc_b64 s[10:11]
    v_lshlrev_b32 v144, 6, v0
    s_mov_b32 s49, Lcode_end-.
    v_min_u32 v144, s49, v144
    v_mov_b32 v145, 0
    v_lshl_add_u64 v[144:145], v[144:145], 0, s[10:11]
    global_load_dword v146, v[144:145], off
    buffer_load_dwordx4 v7, s[12:15], s35 offen lds
    s_add_u32 m0, m0, 0x2000
    s_nop 0
    buffer_load_dwordx4 v7, s[12:15], s36 offen lds
    s_add_u32 m0, m0, 0x2000
Lb0_0:
    s_waitcnt lgkmcnt(0)
    v_mfma_f32_32x32x16_bf16 v[80:95], v[20:23], v[8:11], v[128:143]
    ds_read_b64 v[16:17], v2 offset:512
    ds_read_b64 v[18:19], v2 offset:4608
    ds_read_b64 v[28:29], v2 offset:8704
    s_cbranch_vccz Lp000
    s_setprio 0
Lp000:
    v_exp_f32 v64, v64
    v_exp_f32 v65, v65
    v_exp_f32 v66, v66
    v_exp_f32 v67, v67
    v_mfma_f32_32x32x8_bf16 v[80:95], v[26:27], v[12:13], v[80:95]
    s_mov_b64 exec, s[20:21]
    ds_read_b128 v[32:35], v3 offset:10240
    ds_read_b128 v[36:39], v3 offset:10816
    s_mov_b64 exec, -1
    v_exp_f32 v68, v68
    v_exp_f32 v69, v69
    v_exp_f32 v70, v70
    v_exp_f32 v71, v71
    v_smfmac_f32_32x32x32_bf16 v[48:63], v[40:43], v[112:119], v4
    v_exp_f32 v72, v72
    v_exp_f32 v73, v73
    v_exp_f32 v74, v74
    v_exp_f32 v75, v75
    v_smfmac_f32_32x32x32_bf16 v[48:63], v[44:47], v[120:127], v4
    v_exp_f32 v76, v76
    v_exp_f32 v77, v77
    v_exp_f32 v78, v78
    v_exp_f32 v79, v79
    s_waitcnt lgkmcnt(0)
    v_mfma_f32_32x32x16_bf16 v[96:111], v[16:19], v[8:11], v[128:143]
    ds_read_b64 v[20:21], v2 offset:768
    ds_read_b64 v[22:23], v2 offset:4864
    ds_read_b64 v[30:31], v2 offset:8960
    v_exp_f32 v80, v80
    v_exp_f32 v81, v81
    v_exp_f32 v82, v82
    v_exp_f32 v83, v83
    v_mfma_f32_32x32x8_bf16 v[96:111], v[28:29], v[12:13], v[96:111]
    s_mov_b64 exec, s[20:21]
    ds_read_b128 v[40:43], v3 offset:11392
    ds_read_b128 v[44:47], v3 offset:11968
    s_mov_b64 exec, -1
    v_exp_f32 v84, v84
    v_exp_f32 v85, v85
    v_exp_f32 v86, v86
    v_exp_f32 v87, v87
    v_smfmac_f32_32x32x32_bf16 v[48:63], v[32:35], v[64:71], v4
    v_exp_f32 v88, v88
    v_exp_f32 v89, v89
    v_exp_f32 v90, v90
    v_exp_f32 v91, v91
    v_smfmac_f32_32x32x32_bf16 v[48:63], v[36:39], v[72:79], v4
    v_exp_f32 v92, v92
    v_exp_f32 v93, v93
    v_exp_f32 v94, v94
    v_exp_f32 v95, v95
    buffer_load_dwordx4 v7, s[12:15], s37 offen lds
    s_add_u32 m0, m0, 0x2000
    s_nop 0
    buffer_load_dwordx4 v7, s[12:15], s38 offen lds
    s_add_u32 m0, m0, 0x2000
Lb0_2:
    s_waitcnt lgkmcnt(0)
    v_mfma_f32_32x32x16_bf16 v[112:127], v[20:23], v[8:11], v[128:143]
    ds_read_b64 v[16:17], v2 offset:2048
    ds_read_b64 v[18:19], v2 offset:6144
    v_exp_f32 v96, v96
    v_exp_f32 v97, v97
    v_exp_f32 v98, v98
    v_exp_f32 v99, v99
    v_mfma_f32_32x32x8_bf16 v[112:127], v[30:31], v[12:13], v[112:127]
    s_mov_b64 exec, s[20:21]
    ds_read_b128 v[32:35], v3 offset:12544
    ds_read_b128 v[36:39], v3 offset:13120
    s_mov_b64 exec, -1
    v_exp_f32 v100, v100
    v_exp_f32 v101, v101
    v_exp_f32 v102, v102
    v_exp_f32 v103, v103
    v_smfmac_f32_32x32x32_bf16 v[48:63], v[40:43], v[80:87], v4
    v_exp_f32 v104, v104
    v_exp_f32 v105, v105
    v_exp_f32 v106, v106
    v_exp_f32 v107, v107
    v_smfmac_f32_32x32x32_bf16 v[48:63], v[44:47], v[88:95], v4
    v_exp_f32 v108, v108
    v_exp_f32 v109, v109
    v_exp_f32 v110, v110
    v_exp_f32 v111, v111
    s_waitcnt lgkmcnt(0)
    v_mfma_f32_32x32x16_bf16 v[64:79], v[16:19], v[8:11], v[128:143]
    ds_read_b64 v[20:21], v2 offset:2304
    ds_read_b64 v[22:23], v2 offset:6400
    v_exp_f32 v112, v112
    v_exp_f32 v113, v113
    v_exp_f32 v114, v114
    v_exp_f32 v115, v115
    v_mfma_f32_32x32x8_bf16 v[64:79], v[24:25], v[14:15], v[64:79]
    s_mov_b64 exec, s[20:21]
    ds_read_b128 v[40:43], v3 offset:13696
    ds_read_b128 v[44:47], v3 offset:14272
    s_mov_b64 exec, -1
    v_exp_f32 v116, v116
    v_exp_f32 v117, v117
    v_exp_f32 v118, v118
    v_exp_f32 v119, v119
    v_smfmac_f32_32x32x32_bf16 v[48:63], v[32:35], v[96:103], v4
    v_exp_f32 v120, v120
    v_exp_f32 v121, v121
    v_exp_f32 v122, v122
    v_exp_f32 v123, v123
    v_smfmac_f32_32x32x32_bf16 v[48:63], v[36:39], v[104:111], v4
    v_exp_f32 v124, v124
    v_exp_f32 v125, v125
    v_exp_f32 v126, v126
    v_exp_f32 v127, v127
    buffer_load_dwordx4 v7, s[12:15], s39 offen lds
    s_add_u32 m0, m0, 0x2000
    s_nop 0
    buffer_load_dwordx4 v7, s[12:15], s40 offen lds
    s_add_u32 m0, m0, 0x2000
Lb0_4:
    s_waitcnt lgkmcnt(0)
    v_mfma_f32_32x32x16_bf16 v[80:95], v[20:23], v[8:11], v[128:143]
    ds_read_b64 v[16:17], v2 offset:2560
    ds_read_b64 v[18:19], v2 offset:6656
    v_exp_f32 v64, v64
    v_exp_f32 v65, v65
    v_exp_f32 v66, v66
    v_exp_f32 v67, v67
    v_mfma_f32_32x32x8_bf16 v[80:95], v[26:27], v[14:15], v[80:95]
    s_mov_b64 exec, s[20:21]
    ds_read_b128 v[32:35], v3 offset:14848
    ds_read_b128 v[36:39], v3 offset:15424
    s_mov_b64 exec, -1
    v_exp_f32 v68, v68
    v_exp_f32 v69, v69
    v_exp_f32 v70, v70
    v_exp_f32 v71, v71
    v_smfmac_f32_32x32x32_bf16 v[48:63], v[40:43], v[112:119], v4
    s_cbranch_vccz Lp042
    s_setprio 2
Lp042:
    v_exp_f32 v72, v72
    v_exp_f32 v73, v73
    v_exp_f32 v74, v74
    v_exp_f32 v75, v75
    v_smfmac_f32_32x32x32_bf16 v[48:63], v[44:47], v[120:127], v4
    v_exp_f32 v76, v76
    v_exp_f32 v77, v77
    v_exp_f32 v78, v78
    v_exp_f32 v79, v79
    s_waitcnt lgkmcnt(0)
    v_mfma_f32_32x32x16_bf16 v[96:111], v[16:19], v[8:11], v[128:143]
    ds_read_b64 v[20:21], v2 offset:2816
    ds_read_b64 v[22:23], v2 offset:6912
    v_exp_f32 v80, v80
    v_exp_f32 v81, v81
    v_exp_f32 v82, v82
    v_exp_f32 v83, v83
    v_mfma_f32_32x32x8_bf16 v[96:111], v[28:29], v[14:15], v[96:111]
    s_mov_b64 exec, s[20:21]
    ds_read_b128 v[40:43], v3 offset:16000
    ds_read_b128 v[44:47], v3 offset:16576
    s_mov_b64 exec, -1
    v_exp_f32 v84, v84
    v_exp_f32 v85, v85
    v_exp_f32 v86, v86
    v_exp_f32 v87, v87
    v_smfmac_f32_32x32x32_bf16 v[48:63], v[32:35], v[64:71], v4
    v_exp_f32 v88, v88
    v_exp_f32 v89, v89
    v_exp_f32 v90, v90
    v_exp_f32 v91, v91
    v_smfmac_f32_32x32x32_bf16 v[48:63], v[36:39], v[72:79], v4
    v_exp_f32 v92, v92
    v_exp_f32 v93, v93
    v_exp_f32 v94, v94
    v_exp_f32 v95, v95
    s_waitcnt vmcnt(6)
    s_barrier
    buffer_load_dwordx4 v7, s[12:15], s41 offen lds
    s_add_u32 m0, m0, 0x2000
    s_nop 0
    buffer_load_dwordx4 v7, s[12:15], s42 offen lds
    s_add_u32 m0, m0, 0x2000
Lb0_6:
    s_waitcnt lgkmcnt(0)
    v_mfma_f32_32x32x16_bf16 v[112:127], v[20:23], v[8:11], v[128:143]
    ds_read_b64 v[16:17], v2 offset:19456
    ds_read_b64 v[18:19], v2 offset:23552
    ds_read_b64 v[24:25], v2 offset:27648
    v_exp_f32 v96, v96
    v_exp_f32 v97, v97
    v_exp_f32 v98, v98
    v_exp_f32 v99, v99
    v_mfma_f32_32x32x8_bf16 v[112:127], v[30:31], v[14:15], v[112:127]
    s_mov_b64 exec, s[20:21]
    ds_read_b128 v[32:35], v3 offset:17152
    ds_read_b128 v[36:39], v3 offset:17728
    s_mov_b64 exec, -1
    v_exp_f32 v100, v100
    v_exp_f32 v101, v101
    v_exp_f32 v102, v102
    v_exp_f32 v103, v103
    v_smfmac_f32_32x32x32_bf16 v[48:63], v[40:43], v[80:87], v4
    v_exp_f32 v104, v104
    v_exp_f32 v105, v105
    v_exp_f32 v106, v106
    v_exp_f32 v107, v107
    v_smfmac_f32_32x32x32_bf16 v[48:63], v[44:47], v[88:95], v4
    v_exp_f32 v108, v108
    v_exp_f32 v109, v109
    v_exp_f32 v110, v110
    v_exp_f32 v111, v111
    s_waitcnt lgkmcnt(0)
    v_mfma_f32_32x32x16_bf16 v[64:79], v[16:19], v[8:11], v[128:143]
    ds_read_b64 v[20:21], v2 offset:19712
    ds_read_b64 v[22:23], v2 offset:23808
    ds_read_b64 v[26:27], v2 offset:27904
    v_exp_f32 v112, v112
    v_exp_f32 v113, v113
    v_exp_f32 v114, v114
    v_exp_f32 v115, v115
    v_mfma_f32_32x32x8_bf16 v[64:79], v[24:25], v[12:13], v[64:79]
    s_mov_b64 exec, s[20:21]
    ds_read_b128 v[40:43], v3 offset:18304
    ds_read_b128 v[44:47], v3 offset:18880
    s_mov_b64 exec, -1
    v_exp_f32 v116, v116
    v_exp_f32 v117, v117
    v_exp_f32 v118, v118
    v_exp_f32 v119, v119
    v_smfmac_f32_32x32x32_bf16 v[48:63], v[32:35], v[96:103], v4
    v_add_u32 v2, 19456, v2
    v_add_u32 v3, 19456, v3
    v_exp_f32 v120, v120
    v_exp_f32 v121, v121
    v_exp_f32 v122, v122
    v_exp_f32 v123, v123
    v_smfmac_f32_32x32x32_bf16 v[48:63], v[36:39], v[104:111], v4
    v_exp_f32 v124, v124
    v_exp_f32 v125, v125
    v_exp_f32 v126, v126
    v_exp_f32 v127, v127
    buffer_load_dwordx4 v7, s[12:15], s43 offen lds
    s_add_u32 m0, m0, 0x2000
    s_nop 0
    buffer_load_dwordx4 v7, s[12:15], s44 offen lds
    s_add_u32 m0, m0, 0x2000
Lb1_0:
    s_waitcnt lgkmcnt(0)
    v_mfma_f32_32x32x16_bf16 v[80:95], v[20:23], v[8:11], v[128:143]
    ds_read_b64 v[16:17], v2 offset:512
    ds_read_b64 v[18:19], v2 offset:4608
    ds_read_b64 v[28:29], v2 offset:8704
    s_cbranch_vccz Lp100
    s_setprio 0
Lp100:
    v_exp_f32 v64, v64
    v_exp_f32 v65, v65
    v_exp_f32 v66, v66
    v_exp_f32 v67, v67
    v_mfma_f32_32x32x8_bf16 v[80:95], v[26:27], v[12:13], v[80:95]
    s_mov_b64 exec, s[20:21]
    ds_read_b128 v[32:35], v3 offset:10240
    ds_read_b128 v[36:39], v3 offset:10816
    s_mov_b64 exec, -1
    v_exp_f32 v68, v68
    v_exp_f32 v69, v69
    v_exp_f32 v70, v70
    v_exp_f32 v71, v71
    v_smfmac_f32_32x32x32_bf16 v[48:63], v[40:43], v[112:119], v4
    v_exp_f32 v72, v72
    v_exp_f32 v73, v73
    v_exp_f32 v74, v74
    v_exp_f32 v75, v75
    v_smfmac_f32_32x32x32_bf16 v[48:63], v[44:47], v[120:127], v4
    v_exp_f32 v76, v76
    v_exp_f32 v77, v77
    v_exp_f32 v78, v78
    v_exp_f32 v79, v79
    s_waitcnt lgkmcnt(0)
    v_mfma_f32_32x32x16_bf16 v[96:111], v[16:19], v[8:11], v[128:143]
    ds_read_b64 v[20:21], v2 offset:768
    ds_read_b64 v[22:23], v2 offset:4864
    ds_read_b64 v[30:31], v2 offset:8960
    v_exp_f32 v80, v80
    v_exp_f32 v81, v81
    v_exp_f32 v82, v82
    v_exp_f32 v83, v83
    v_mfma_f32_32x32x8_bf16 v[96:111], v[28:29], v[12:13], v[96:111]
    s_mov_b64 exec, s[20:21]
    ds_read_b128 v[40:43], v3 offset:11392
    ds_read_b128 v[44:47], v3 offset:11968
    s_mov_b64 exec, -1
    v_exp_f32 v84, v84
    v_exp_f32 v85, v85
    v_exp_f32 v86, v86
    v_exp_f32 v87, v87
    v_smfmac_f32_32x32x32_bf16 v[48:63], v[32:35], v[64:71], v4
    v_exp_f32 v88, v88
    v_exp_f32 v89, v89
    v_exp_f32 v90, v90
    v_exp_f32 v91, v91
    v_smfmac_f32_32x32x32_bf16 v[48:63], v[36:39], v[72:79], v4
    v_exp_f32 v92, v92
    v_exp_f32 v93, v93
    v_exp_f32 v94, v94
    v_exp_f32 v95, v95
    buffer_load_dwordx4 v7, s[12:15], s45 offen lds
    s_add_u32 m0, m0, 0x2000
    s_nop 0
    buffer_load_dwordx4 v7, s[12:15], s46 offen lds
    s_add_u32 m0, m0, 0x2000
Lb1_2:
    s_waitcnt lgkmcnt(0)
    v_mfma_f32_32x32x16_bf16 v[112:127], v[20:23], v[8:11], v[128:143]
    ds_read_b64 v[16:17], v2 offset:2048
    ds_read_b64 v[18:19], v2 offset:6144
    v_exp_f32 v96, v96
    v_exp_f32 v97, v97
    v_exp_f32 v98, v98
    v_exp_f32 v99, v99
    v_mfma_f32_32x32x8_bf16 v[112:127], v[30:31], v[12:13], v[112:127]
    s_mov_b64 exec, s[20:21]
    ds_read_b128 v[32:35], v3 offset:12544
    ds_read_b128 v[36:39], v3 offset:13120
    s_mov_b64 exec, -1
    v_exp_f32 v100, v100
    v_exp_f32 v101, v101
    v_exp_f32 v102, v102
    v_exp_f32 v103, v103
    v_smfmac_f32_32x32x32_bf16 v[48:63], v[40:43], v[80:87], v4
    v_exp_f32 v104, v104
    v_exp_f32 v105, v105
    v_exp_f32 v106, v106
    v_exp_f32 v107, v107
    v_smfmac_f32_32x32x32_bf16 v[48:63], v[44:47], v[88:95], v4
    v_exp_f32 v108, v108
    v_exp_f32 v109, v109
    v_exp_f32 v110, v110
    v_exp_f32 v111, v111
    s_waitcnt lgkmcnt(0)
    v_mfma_f32_32x32x16_bf16 v[64:79], v[16:19], v[8:11], v[128:143]
    ds_read_b64 v[20:21], v2 offset:2304
    ds_read_b64 v[22:23], v2 offset:6400
    v_exp_f32 v112, v112
    v_exp_f32 v113, v113
    v_exp_f32 v114, v114
    v_exp_f32 v115, v115
    v_mfma_f32_32x32x8_bf16 v[64:79], v[24:25], v[14:15], v[64:79]
    s_mov_b64 exec, s[20:21]
    ds_read_b128 v[40:43], v3 offset:13696
    ds_read_b128 v[44:47], v3 offset:14272
    s_mov_b64 exec, -1
    v_exp_f32 v116, v116
    v_exp_f32 v117, v117
    v_exp_f32 v118, v118
    v_exp_f32 v119, v119
    v_smfmac_f32_32x32x32_bf16 v[48:63], v[32:35], v[96:103], v4
    v_exp_f32 v120, v120
    v_exp_f32 v121, v121
    v_exp_f32 v122, v122
    v_exp_f32 v123, v123
    v_smfmac_f32_32x32x32_bf16 v[48:63], v[36:39], v[104:111], v4
    v_exp_f32 v124, v124
    v_exp_f32 v125, v125
    v_exp_f32 v126, v126
    v_exp_f32 v127, v127
    buffer_load_dwordx4 v7, s[12:15], s47 offen lds
    s_add_u32 m0, m0, 0x2000
    s_nop 0
    buffer_load_dwordx4 v7, s[12:15], s48 offen lds
Lb1_4:
    s_waitcnt lgkmcnt(0)
    v_mfma_f32_32x32x16_bf16 v[80:95], v[20:23], v[8:11], v[128:143]
    ds_read_b64 v[16:17], v2 offset:2560
    ds_read_b64 v[18:19], v2 offset:6656
    v_exp_f32 v64, v64
    v_exp_f32 v65, v65
    v_exp_f32 v66, v66
    v_exp_f32 v67, v67
    v_mfma_f32_32x32x8_bf16 v[80:95], v[26:27], v[14:15], v[80:95]
    s_mov_b64 exec, s[20:21]
    ds_read_b128 v[32:35], v3 offset:14848
    ds_read_b128 v[36:39], v3 offset:15424
    s_mov_b64 exec, -1
    v_exp_f32 v68, v68
    v_exp_f32 v69, v69
    v_exp_f32 v70, v70
    v_exp_f32 v71, v71
    v_smfmac_f32_32x32x32_bf16 v[48:63], v[40:43], v[112:119], v4
    s_cbranch_vccz Lp142
    s_setprio 2
Lp142:
    v_exp_f32 v72, v72
    v_exp_f32 v73, v73
    v_exp_f32 v74, v74
    v_exp_f32 v75, v75
    v_smfmac_f32_32x32x32_bf16 v[48:63], v[44:47], v[120:127], v4
    v_exp_f32 v76, v76
    v_exp_f32 v77, v77
    v_exp_f32 v78, v78
    v_exp_f32 v79, v79
    s_waitcnt lgkmcnt(0)
    v_mfma_f32_32x32x16_bf16 v[96:111], v[16:19], v[8:11], v[128:143]
    ds_read_b64 v[20:21], v2 offset:2816
    ds_read_b64 v[22:23], v2 offset:6912
    v_exp_f32 v80, v80
    v_exp_f32 v81, v81
    v_exp_f32 v82, v82
    v_exp_f32 v83, v83
    v_mfma_f32_32x32x8_bf16 v[96:111], v[28:29], v[14:15], v[96:111]
    s_mov_b64 exec, s[20:21]
    ds_read_b128 v[40:43], v3 offset:16000
    ds_read_b128 v[44:47], v3 offset:16576
    s_mov_b64 exec, -1
    v_exp_f32 v84, v84
    v_exp_f32 v85, v85
    v_exp_f32 v86, v86
    v_exp_f32 v87, v87
    v_smfmac_f32_32x32x32_bf16 v[48:63], v[32:35], v[64:71], v4
    v_exp_f32 v88, v88
    v_exp_f32 v89, v89
    v_exp_f32 v90, v90
    v_exp_f32 v91, v91
    v_smfmac_f32_32x32x32_bf16 v[48:63], v[36:39], v[72:79], v4
    v_exp_f32 v92, v92
    v_exp_f32 v93, v93
    v_exp_f32 v94, v94
    v_exp_f32 v95, v95
    s_waitcnt vmcnt(11)
    s_barrier
    s_cmp_eq_u32 s60, 0
    s_cbranch_scc1 Lb1_6
    buffer_load_dwordx2 v[144:145], v5, s[64:67], s72 offen nt
    s_add_u32 s80, s72, s71
    buffer_load_dwordx2 v[146:147], v5, s[64:67], s80 offen nt
    s_add_u32 s80, s72, s70
    buffer_load_dwordx2 v[148:149], v5, s[64:67], s80 offen nt
    s_add_u32 s80, s72, s70
    s_add_u32 s80, s80, s71
    buffer_load_dwordx2 v[150:151], v5, s[64:67], s80 offen nt
Lb1_6:
    s_waitcnt lgkmcnt(0)
    v_mfma_f32_32x32x16_bf16 v[112:127], v[20:23], v[8:11], v[128:143]
    ds_read_b64 v[16:17], v2 offset:19456
    ds_read_b64 v[18:19], v2 offset:23552
    ds_read_b64 v[24:25], v2 offset:27648
    v_exp_f32 v96, v96
    v_exp_f32 v97, v97
    v_exp_f32 v98, v98
    v_exp_f32 v99, v99
    v_mfma_f32_32x32x8_bf16 v[112:127], v[30:31], v[14:15], v[112:127]
    s_mov_b64 exec, s[20:21]
    ds_read_b128 v[32:35], v3 offset:17152
    ds_read_b128 v[36:39], v3 offset:17728
    s_mov_b64 exec, -1
    v_exp_f32 v100, v100
    v_exp_f32 v101, v101
    v_exp_f32 v102, v102
    v_exp_f32 v103, v103
    v_smfmac_f32_32x32x32_bf16 v[48:63], v[40:43], v[80:87], v4
    v_exp_f32 v104, v104
    v_exp_f32 v105, v105
    v_exp_f32 v106, v106
    v_exp_f32 v107, v107
    v_smfmac_f32_32x32x32_bf16 v[48:63], v[44:47], v[88:95], v4
    v_exp_f32 v108, v108
    v_exp_f32 v109, v109
    v_exp_f32 v110, v110
    v_exp_f32 v111, v111
    s_waitcnt lgkmcnt(0)
    v_mfma_f32_32x32x16_bf16 v[64:79], v[16:19], v[8:11], v[128:143]
    ds_read_b64 v[20:21], v2 offset:19712
    ds_read_b64 v[22:23], v2 offset:23808
    ds_read_b64 v[26:27], v2 offset:27904
    v_exp_f32 v112, v112
    v_exp_f32 v113, v113
    v_exp_f32 v114, v114
    v_exp_f32 v115, v115
    v_mfma_f32_32x32x8_bf16 v[64:79], v[24:25], v[12:13], v[64:79]
    s_mov_b64 exec, s[20:21]
    ds_read_b128 v[40:43], v3 offset:18304
    ds_read_b128 v[44:47], v3 offset:18880
    s_mov_b64 exec, -1
    v_exp_f32 v116, v116
    v_exp_f32 v117, v117
    v_exp_f32 v118, v118
    v_exp_f32 v119, v119
    v_smfmac_f32_32x32x32_bf16 v[48:63], v[32:35], v[96:103], v4
    v_add_u32 v2, 19456, v2
    v_add_u32 v3, 19456, v3
    v_exp_f32 v120, v120
    v_exp_f32 v121, v121
    v_exp_f32 v122, v122
    v_exp_f32 v123, v123
    v_smfmac_f32_32x32x32_bf16 v[48:63], v[36:39], v[104:111], v4
    v_exp_f32 v124, v124
    v_exp_f32 v125, v125
    v_exp_f32 v126, v126
    v_exp_f32 v127, v127
    s_cmp_eq_u32 s60, 0
    s_cbranch_scc1 Lb2_0
    s_add_u32 s80, s72, s69
    buffer_load_dwordx2 v[152:153], v5, s[64:67], s80 offen nt
    s_add_u32 s80, s72, s69
    s_add_u32 s80, s80, s71
    buffer_load_dwordx2 v[154:155], v5, s[64:67], s80 offen nt
    s_add_u32 s80, s72, s69
    s_add_u32 s80, s80, s70
    buffer_load_dwordx2 v[156:157], v5, s[64:67], s80 offen nt
    s_add_u32 s80, s72, s69
    s_add_u32 s80, s80, s70
    s_add_u32 s80, s80, s71
    buffer_load_dwordx2 v[158:159], v5, s[64:67], s80 offen nt
Lb2_0:
    s_waitcnt lgkmcnt(0)
    v_mfma_f32_32x32x16_bf16 v[80:95], v[20:23], v[8:11], v[128:143]
    ds_read_b64 v[16:17], v2 offset:512
    ds_read_b64 v[18:19], v2 offset:4608
    ds_read_b64 v[28:29], v2 offset:8704
    s_cbranch_vccz Lp200
    s_setprio 0
Lp200:
    v_exp_f32 v64, v64
    v_exp_f32 v65, v65
    v_exp_f32 v66, v66
    v_exp_f32 v67, v67
    v_mfma_f32_32x32x8_bf16 v[80:95], v[26:27], v[12:13], v[80:95]
    s_mov_b64 exec, s[20:21]
    ds_read_b128 v[32:35], v3 offset:10240
    ds_read_b128 v[36:39], v3 offset:10816
    s_mov_b64 exec, -1
    v_exp_f32 v68, v68
    v_exp_f32 v69, v69
    v_exp_f32 v70, v70
    v_exp_f32 v71, v71
    v_smfmac_f32_32x32x32_bf16 v[48:63], v[40:43], v[112:119], v4
    v_exp_f32 v72, v72
    v_exp_f32 v73, v73
    v_exp_f32 v74, v74
    v_exp_f32 v75, v75
    v_smfmac_f32_32x32x32_bf16 v[48:63], v[44:47], v[120:127], v4
    v_exp_f32 v76, v76
    v_exp_f32 v77, v77
    v_exp_f32 v78, v78
    v_exp_f32 v79, v79
    s_waitcnt lgkmcnt(0)
    v_mfma_f32_32x32x16_bf16 v[96:111], v[16:19], v[8:11], v[128:143]
    ds_read_b64 v[20:21], v2 offset:768
    ds_read_b64 v[22:23], v2 offset:4864
    ds_read_b64 v[30:31], v2 offset:8960
    v_exp_f32 v80, v80
    v_exp_f32 v81, v81
    v_exp_f32 v82, v82
    v_exp_f32 v83, v83
    v_mfma_f32_32x32x8_bf16 v[96:111], v[28:29], v[12:13], v[96:111]
    s_mov_b64 exec, s[20:21]
    ds_read_b128 v[40:43], v3 offset:11392
    ds_read_b128 v[44:47], v3 offset:11968
    s_mov_b64 exec, -1
    v_exp_f32 v84, v84
    v_exp_f32 v85, v85
    v_exp_f32 v86, v86
    v_exp_f32 v87, v87
    v_smfmac_f32_32x32x32_bf16 v[48:63], v[32:35], v[64:71], v4
    v_exp_f32 v88, v88
    v_exp_f32 v89, v89
    v_exp_f32 v90, v90
    v_exp_f32 v91, v91
    v_smfmac_f32_32x32x32_bf16 v[48:63], v[36:39], v[72:79], v4
    v_exp_f32 v92, v92
    v_exp_f32 v93, v93
    v_exp_f32 v94, v94
    v_exp_f32 v95, v95
    s_cmp_eq_u32 s60, 0
    s_cbranch_scc1 Lb2_2
    s_add_u32 s80, s72, s68
    buffer_load_dwordx2 v[160:161], v5, s[64:67], s80 offen nt
    s_add_u32 s80, s72, s68
    s_add_u32 s80, s80, s71
    buffer_load_dwordx2 v[162:163], v5, s[64:67], s80 offen nt
    s_add_u32 s80, s72, s68
    s_add_u32 s80, s80, s70
    buffer_load_dwordx2 v[164:165], v5, s[64:67], s80 offen nt
    s_add_u32 s80, s72, s68
    s_add_u32 s80, s80, s70
    s_add_u32 s80, s80, s71
    buffer_load_dwordx2 v[166:167], v5, s[64:67], s80 offen nt
Lb2_2:
    s_waitcnt lgkmcnt(0)
    v_mfma_f32_32x32x16_bf16 v[112:127], v[20:23], v[8:11], v[128:143]
    ds_read_b64 v[16:17], v2 offset:2048
    ds_read_b64 v[18:19], v2 offset:6144
    v_exp_f32 v96, v96
    v_exp_f32 v97, v97
    v_exp_f32 v98, v98
    v_exp_f32 v99, v99
    v_mfma_f32_32x32x8_bf16 v[112:127], v[30:31], v[12:13], v[112:127]
    s_mov_b64 exec, s[20:21]
    ds_read_b128 v[32:35], v3 offset:12544
    ds_read_b128 v[36:39], v3 offset:13120
    s_mov_b64 exec, -1
    v_exp_f32 v100, v100
    v_exp_f32 v101, v101
    v_exp_f32 v102, v102
    v_exp_f32 v103, v103
    v_smfmac_f32_32x32x32_bf16 v[48:63], v[40:43], v[80:87], v4
    v_exp_f32 v104, v104
    v_exp_f32 v105, v105
    v_exp_f32 v106, v106
    v_exp_f32 v107, v107
    v_smfmac_f32_32x32x32_bf16 v[48:63], v[44:47], v[88:95], v4
    v_exp_f32 v108, v108
    v_exp_f32 v109, v109
    v_exp_f32 v110, v110
    v_exp_f32 v111, v111
    s_waitcnt lgkmcnt(0)
    v_mfma_f32_32x32x16_bf16 v[64:79], v[16:19], v[8:11], v[128:143]
    ds_read_b64 v[20:21], v2 offset:2304
    ds_read_b64 v[22:23], v2 offset:6400
    v_exp_f32 v112, v112
    v_exp_f32 v113, v113
    v_exp_f32 v114, v114
    v_exp_f32 v115, v115
    v_mfma_f32_32x32x8_bf16 v[64:79], v[24:25], v[14:15], v[64:79]
    s_mov_b64 exec, s[20:21]
    ds_read_b128 v[40:43], v3 offset:13696
    ds_read_b128 v[44:47], v3 offset:14272
    s_mov_b64 exec, -1
    v_exp_f32 v116, v116
    v_exp_f32 v117, v117
    v_exp_f32 v118, v118
    v_exp_f32 v119, v119
    v_smfmac_f32_32x32x32_bf16 v[48:63], v[32:35], v[96:103], v4
    v_exp_f32 v120, v120
    v_exp_f32 v121, v121
    v_exp_f32 v122, v122
    v_exp_f32 v123, v123
    v_smfmac_f32_32x32x32_bf16 v[48:63], v[36:39], v[104:111], v4
    v_exp_f32 v124, v124
    v_exp_f32 v125, v125
    v_exp_f32 v126, v126
    v_exp_f32 v127, v127
    s_cmp_eq_u32 s60, 0
    s_cbranch_scc1 Lb2_4
    s_add_u32 s80, s72, s68
    s_add_u32 s80, s80, s69
    buffer_load_dwordx2 v[168:169], v5, s[64:67], s80 offen nt
    s_add_u32 s80, s72, s68
    s_add_u32 s80, s80, s69
    s_add_u32 s80, s80, s71
    buffer_load_dwordx2 v[170:171], v5, s[64:67], s80 offen nt
    s_add_u32 s80, s72, s68
    s_add_u32 s80, s80, s69
    s_add_u32 s80, s80, s70
    buffer_load_dwordx2 v[172:173], v5, s[64:67], s80 offen nt
    s_add_u32 s80, s72, s68
    s_add_u32 s80, s80, s69
    s_add_u32 s80, s80, s70
    s_add_u32 s80, s80, s71
    buffer_load_dwordx2 v[174:175], v5, s[64:67], s80 offen nt
Lb2_4:
    s_waitcnt lgkmcnt(0)
    v_mfma_f32_32x32x16_bf16 v[80:95], v[20:23], v[8:11], v[128:143]
    ds_read_b64 v[16:17], v2 offset:2560
    ds_read_b64 v[18:19], v2 offset:6656
    v_exp_f32 v64, v64
    v_exp_f32 v65, v65
    v_exp_f32 v66, v66
    v_exp_f32 v67, v67
    v_mfma_f32_32x32x8_bf16 v[80:95], v[26:27], v[14:15], v[80:95]
    s_mov_b64 exec, s[20:21]
    ds_read_b128 v[32:35], v3 offset:14848
    ds_read_b128 v[36:39], v3 offset:15424
    s_mov_b64 exec, -1
    v_exp_f32 v68, v68
    v_exp_f32 v69, v69
    v_exp_f32 v70, v70
    v_exp_f32 v71, v71
    v_smfmac_f32_32x32x32_bf16 v[48:63], v[40:43], v[112:119], v4
    s_cbranch_vccz Lp242
    s_setprio 2
Lp242:
    v_exp_f32 v72, v72
    v_exp_f32 v73, v73
    v_exp_f32 v74, v74
    v_exp_f32 v75, v75
    v_smfmac_f32_32x32x32_bf16 v[48:63], v[44:47], v[120:127], v4
    v_exp_f32 v76, v76
    v_exp_f32 v77, v77
    v_exp_f32 v78, v78
    v_exp_f32 v79, v79
    s_waitcnt lgkmcnt(0)
    v_mfma_f32_32x32x16_bf16 v[96:111], v[16:19], v[8:11], v[128:143]
    ds_read_b64 v[20:21], v2 offset:2816
    ds_read_b64 v[22:23], v2 offset:6912
    v_exp_f32 v80, v80
    v_exp_f32 v81, v81
    v_exp_f32 v82, v82
    v_exp_f32 v83, v83
    v_mfma_f32_32x32x8_bf16 v[96:111], v[28:29], v[14:15], v[96:111]
    s_mov_b64 exec, s[20:21]
    ds_read_b128 v[40:43], v3 offset:16000
    ds_read_b128 v[44:47], v3 offset:16576
    s_mov_b64 exec, -1
    v_exp_f32 v84, v84
    v_exp_f32 v85, v85
    v_exp_f32 v86, v86
    v_exp_f32 v87, v87
    v_smfmac_f32_32x32x32_bf16 v[48:63], v[32:35], v[64:71], v4
    v_exp_f32 v88, v88
    v_exp_f32 v89, v89
    v_exp_f32 v90, v90
    v_exp_f32 v91, v91
    v_smfmac_f32_32x32x32_bf16 v[48:63], v[36:39], v[72:79], v4
    v_exp_f32 v92, v92
    v_exp_f32 v93, v93
    v_exp_f32 v94, v94
    v_exp_f32 v95, v95
    s_waitcnt vmcnt(16)
    s_cmp_lg_u32 s60, 0
    s_cbranch_scc1 Lh23
    s_waitcnt vmcnt(0)
Lh23:
    s_barrier
Lb2_6:
    s_waitcnt lgkmcnt(0)
    v_mfma_f32_32x32x16_bf16 v[112:127], v[20:23], v[8:11], v[128:143]
    ds_read_b64 v[16:17], v2 offset:19456
    ds_read_b64 v[18:19], v2 offset:23552
    ds_read_b64 v[24:25], v2 offset:27648
    v_exp_f32 v96, v96
    v_exp_f32 v97, v97
    v_exp_f32 v98, v98
    v_exp_f32 v99, v99
    v_mfma_f32_32x32x8_bf16 v[112:127], v[30:31], v[14:15], v[112:127]
    s_mov_b64 exec, s[20:21]
    ds_read_b128 v[32:35], v3 offset:17152
    ds_read_b128 v[36:39], v3 offset:17728
    s_mov_b64 exec, -1
    v_exp_f32 v100, v100
    v_exp_f32 v101, v101
    v_exp_f32 v102, v102
    v_exp_f32 v103, v103
    v_smfmac_f32_32x32x32_bf16 v[48:63], v[40:43], v[80:87], v4
    v_exp_f32 v104, v104
    v_exp_f32 v105, v105
    v_exp_f32 v106, v106
    v_exp_f32 v107, v107
    v_smfmac_f32_32x32x32_bf16 v[48:63], v[44:47], v[88:95], v4
    v_exp_f32 v108, v108
    v_exp_f32 v109, v109
    v_exp_f32 v110, v110
    v_exp_f32 v111, v111
    s_waitcnt lgkmcnt(0)
    v_mfma_f32_32x32x16_bf16 v[64:79], v[16:19], v[8:11], v[128:143]
    ds_read_b64 v[20:21], v2 offset:19712
    ds_read_b64 v[22:23], v2 offset:23808
    ds_read_b64 v[26:27], v2 offset:27904
    v_exp_f32 v112, v112
    v_exp_f32 v113, v113
    v_exp_f32 v114, v114
    v_exp_f32 v115, v115
    v_mfma_f32_32x32x8_bf16 v[64:79], v[24:25], v[12:13], v[64:79]
    s_mov_b64 exec, s[20:21]
    ds_read_b128 v[40:43], v3 offset:18304
    ds_read_b128 v[44:47], v3 offset:18880
    s_mov_b64 exec, -1
    v_exp_f32 v116, v116
    v_exp_f32 v117, v117
    v_exp_f32 v118, v118
    v_exp_f32 v119, v119
    v_smfmac_f32_32x32x32_bf16 v[48:63], v[32:35], v[96:103], v4
    v_add_u32 v2, 19456, v2
    v_add_u32 v3, 19456, v3
    v_exp_f32 v120, v120
    v_exp_f32 v121, v121
    v_exp_f32 v122, v122
    v_exp_f32 v123, v123
    v_smfmac_f32_32x32x32_bf16 v[48:63], v[36:39], v[104:111], v4
    v_exp_f32 v124, v124
    v_exp_f32 v125, v125
    v_exp_f32 v126, v126
    v_exp_f32 v127, v127
    s_cmp_eq_u32 s60, 0
    s_cbranch_scc1 Lb3_0
    s_waitcnt vmcnt(8)
    v_perm_b32 v176, v146, v144, s82
    v_perm_b32 v177, v150, v148, s82
    v_perm_b32 v178, v154, v152, s82
    v_perm_b32 v179, v158, v156, s82
    v_perm_b32 v180, v146, v144, s83
    v_perm_b32 v181, v150, v148, s83
    v_perm_b32 v182, v154, v152, s83
    v_perm_b32 v183, v158, v156, s83
    v_perm_b32 v184, v147, v145, s82
    v_perm_b32 v185, v151, v149, s82
    v_perm_b32 v186, v155, v153, s82
    v_perm_b32 v187, v159, v157, s82
    v_perm_b32 v188, v147, v145, s83
    v_perm_b32 v189, v151, v149, s83
    v_perm_b32 v190, v155, v153, s83
    v_perm_b32 v191, v159, v157, s83
    s_cmp_eq_u32 s60, 1
    s_cbranch_scc1 Lh30
    v_permlane32_swap_b32 v176, v184
    v_permlane32_swap_b32 v177, v185
    v_permlane32_swap_b32 v178, v186
    v_permlane32_swap_b32 v179, v187
    v_permlane32_swap_b32 v180, v188
    v_permlane32_swap_b32 v181, v189
    v_permlane32_swap_b32 v182, v190
    v_permlane32_swap_b32 v183, v191
    v_permlane16_swap_b32 v176, v180
    v_permlane16_swap_b32 v177, v181
    v_permlane16_swap_b32 v178, v182
    v_permlane16_swap_b32 v179, v183
    v_permlane16_swap_b32 v184, v188
    v_permlane16_swap_b32 v185, v189
    v_permlane16_swap_b32 v186, v190
    v_permlane16_swap_b32 v187, v191
Lh30:
    buffer_store_dwordx4 v[176:179], v6, s[12:15], s76 offen sc1
    buffer_store_dwordx4 v[180:183], v6, s[12:15], s77 offen sc1
Lb3_0:
    s_waitcnt lgkmcnt(0)
    v_mfma_f32_32x32x16_bf16 v[80:95], v[20:23], v[8:11], v[128:143]
    ds_read_b64 v[16:17], v2 offset:512
    ds_read_b64 v[18:19], v2 offset:4608
    ds_read_b64 v[28:29], v2 offset:8704
    s_cbranch_vccz Lp300
    s_setprio 0
Lp300:
    v_exp_f32 v64, v64
    v_exp_f32 v65, v65
    v_exp_f32 v66, v66
    v_exp_f32 v67, v67
    v_mfma_f32_32x32x8_bf16 v[80:95], v[26:27], v[12:13], v[80:95]
    s_mov_b64 exec, s[20:21]
    ds_read_b128 v[32:35], v3 offset:10240
    ds_read_b128 v[36:39], v3 offset:10816
    s_mov_b64 exec, -1
    v_exp_f32 v68, v68
    v_exp_f32 v69, v69
    v_exp_f32 v70, v70
    v_exp_f32 v71, v71
    v_smfmac_f32_32x32x32_bf16 v[48:63], v[40:43], v[112:119], v4
    v_exp_f32 v72, v72
    v_exp_f32 v73, v73
    v_exp_f32 v74, v74
    v_exp_f32 v75, v75
    v_smfmac_f32_32x32x32_bf16 v[48:63], v[44:47], v[120:127], v4
    v_exp_f32 v76, v76
    v_exp_f32 v77, v77
    v_exp_f32 v78, v78
    v_exp_f32 v79, v79
    s_waitcnt lgkmcnt(0)
    v_mfma_f32_32x32x16_bf16 v[96:111], v[16:19], v[8:11], v[128:143]
    ds_read_b64 v[20:21], v2 offset:768
    ds_read_b64 v[22:23], v2 offset:4864
    ds_read_b64 v[30:31], v2 offset:8960
    v_exp_f32 v80, v80
    v_exp_f32 v81, v81
    v_exp_f32 v82, v82
    v_exp_f32 v83, v83
    v_mfma_f32_32x32x8_bf16 v[96:111], v[28:29], v[12:13], v[96:111]
    s_mov_b64 exec, s[20:21]
    ds_read_b128 v[40:43], v3 offset:11392
    ds_read_b128 v[44:47], v3 offset:11968
    s_mov_b64 exec, -1
    v_exp_f32 v84, v84
    v_exp_f32 v85, v85
    v_exp_f32 v86, v86
    v_exp_f32 v87, v87
    v_smfmac_f32_32x32x32_bf16 v[48:63], v[32:35], v[64:71], v4
    v_exp_f32 v88, v88
    v_exp_f32 v89, v89
    v_exp_f32 v90, v90
    v_exp_f32 v91, v91
    v_smfmac_f32_32x32x32_bf16 v[48:63], v[36:39], v[72:79], v4
    v_exp_f32 v92, v92
    v_exp_f32 v93, v93
    v_exp_f32 v94, v94
    v_exp_f32 v95, v95
    s_cmp_eq_u32 s60, 0
    s_cbranch_scc1 Lb3_2
    buffer_store_dwordx4 v[184:187], v6, s[12:15], s78 offen sc1
    buffer_store_dwordx4 v[188:191], v6, s[12:15], s79 offen sc1
Lb3_2:
    s_waitcnt lgkmcnt(0)
    v_mfma_f32_32x32x16_bf16 v[112:127], v[20:23], v[8:11], v[128:143]
    ds_read_b64 v[16:17], v2 offset:2048
    ds_read_b64 v[18:19], v2 offset:6144
    v_exp_f32 v96, v96
    v_exp_f32 v97, v97
    v_exp_f32 v98, v98
    v_exp_f32 v99, v99
    v_mfma_f32_32x32x8_bf16 v[112:127], v[30:31], v[12:13], v[112:127]
    s_mov_b64 exec, s[20:21]
    ds_read_b128 v[32:35], v3 offset:12544
    ds_read_b128 v[36:39], v3 offset:13120
    s_mov_b64 exec, -1
    v_exp_f32 v100, v100
    v_exp_f32 v101, v101
    v_exp_f32 v102, v102
    v_exp_f32 v103, v103
    v_smfmac_f32_32x32x32_bf16 v[48:63], v[40:43], v[80:87], v4
    v_exp_f32 v104, v104
    v_exp_f32 v105, v105
    v_exp_f32 v106, v106
    v_exp_f32 v107, v107
    v_smfmac_f32_32x32x32_bf16 v[48:63], v[44:47], v[88:95], v4
    v_exp_f32 v108, v108
    v_exp_f32 v109, v109
    v_exp_f32 v110, v110
    v_exp_f32 v111, v111
    s_waitcnt lgkmcnt(0)
    v_mfma_f32_32x32x16_bf16 v[64:79], v[16:19], v[8:11], v[128:143]
    ds_read_b64 v[20:21], v2 offset:2304
    ds_read_b64 v[22:23], v2 offset:6400
    v_exp_f32 v112, v112
    v_exp_f32 v113, v113
    v_exp_f32 v114, v114
    v_exp_f32 v115, v115
    v_mfma_f32_32x32x8_bf16 v[64:79], v[24:25], v[14:15], v[64:79]
    s_mov_b64 exec, s[20:21]
    ds_read_b128 v[40:43], v3 offset:13696
    ds_read_b128 v[44:47], v3 offset:14272
    s_mov_b64 exec, -1
    v_exp_f32 v116, v116
    v_exp_f32 v117, v117
    v_exp_f32 v118, v118
    v_exp_f32 v119, v119
    v_smfmac_f32_32x32x32_bf16 v[48:63], v[32:35], v[96:103], v4
    v_exp_f32 v120, v120
    v_exp_f32 v121, v121
    v_exp_f32 v122, v122
    v_exp_f32 v123, v123
    v_smfmac_f32_32x32x32_bf16 v[48:63], v[36:39], v[104:111], v4
    v_exp_f32 v124, v124
    v_exp_f32 v125, v125
    v_exp_f32 v126, v126
    v_exp_f32 v127, v127
    s_cmp_eq_u32 s60, 0
    s_cbranch_scc1 Lb3_4
    s_waitcnt vmcnt(4)
    v_perm_b32 v192, v162, v160, s82
    v_perm_b32 v193, v166, v164, s82
    v_perm_b32 v194, v170, v168, s82
    v_perm_b32 v195, v174, v172, s82
    v_perm_b32 v196, v162, v160, s83
    v_perm_b32 v197, v166, v164, s83
    v_perm_b32 v198, v170, v168, s83
    v_perm_b32 v199, v174, v172, s83
    v_perm_b32 v200, v163, v161, s82
    v_perm_b32 v201, v167, v165, s82
    v_perm_b32 v202, v171, v169, s82
    v_perm_b32 v203, v175, v173, s82
    v_perm_b32 v204, v163, v161, s83
    v_perm_b32 v205, v167, v165, s83
    v_perm_b32 v206, v171, v169, s83
    v_perm_b32 v207, v175, v173, s83
    s_cmp_eq_u32 s60, 1
    s_cbranch_scc1 Lh32
    v_permlane32_swap_b32 v192, v200
    v_permlane32_swap_b32 v193, v201
    v_permlane32_swap_b32 v194, v202
    v_permlane32_swap_b32 v195, v203
    v_permlane32_swap_b32 v196, v204
    v_permlane32_swap_b32 v197, v205
    v_permlane32_swap_b32 v198, v206
    v_permlane32_swap_b32 v199, v207
    v_permlane16_swap_b32 v192, v196
    v_permlane16_swap_b32 v193, v197
    v_permlane16_swap_b32 v194, v198
    v_permlane16_swap_b32 v195, v199
    v_permlane16_swap_b32 v200, v204
    v_permlane16_swap_b32 v201, v205
    v_permlane16_swap_b32 v202, v206
    v_permlane16_swap_b32 v203, v207
Lh32:
    s_add_u32 s76, s76, s73
    buffer_store_dwordx4 v[192:195], v6, s[12:15], s76 offen sc1
    s_add_u32 s77, s77, s73
    buffer_store_dwordx4 v[196:199], v6, s[12:15], s77 offen sc1
Lb3_4:
    s_waitcnt lgkmcnt(0)
    v_mfma_f32_32x32x16_bf16 v[80:95], v[20:23], v[8:11], v[128:143]
    ds_read_b64 v[16:17], v2 offset:2560
    ds_read_b64 v[18:19], v2 offset:6656
    v_exp_f32 v64, v64
    v_exp_f32 v65, v65
    v_exp_f32 v66, v66
    v_exp_f32 v67, v67
    v_mfma_f32_32x32x8_bf16 v[80:95], v[26:27], v[14:15], v[80:95]
    s_mov_b64 exec, s[20:21]
    ds_read_b128 v[32:35], v3 offset:14848
    ds_read_b128 v[36:39], v3 offset:15424
    s_mov_b64 exec, -1
    v_exp_f32 v68, v68
    v_exp_f32 v69, v69
    v_exp_f32 v70, v70
    v_exp_f32 v71, v71
    v_smfmac_f32_32x32x32_bf16 v[48:63], v[40:43], v[112:119], v4
    s_cbranch_vccz Lp342
    s_setprio 2
Lp342:
    v_exp_f32 v72, v72
    v_exp_f32 v73, v73
    v_exp_f32 v74, v74
    v_exp_f32 v75, v75
    v_smfmac_f32_32x32x32_bf16 v[48:63], v[44:47], v[120:127], v4
    v_exp_f32 v76, v76
    v_exp_f32 v77, v77
    v_exp_f32 v78, v78
    v_exp_f32 v79, v79
    s_waitcnt lgkmcnt(0)
    v_mfma_f32_32x32x16_bf16 v[96:111], v[16:19], v[8:11], v[128:143]
    ds_read_b64 v[20:21], v2 offset:2816
    ds_read_b64 v[22:23], v2 offset:6912
    v_exp_f32 v80, v80
    v_exp_f32 v81, v81
    v_exp_f32 v82, v82
    v_exp_f32 v83, v83
    v_mfma_f32_32x32x8_bf16 v[96:111], v[28:29], v[14:15], v[96:111]
    s_mov_b64 exec, s[20:21]
    ds_read_b128 v[40:43], v3 offset:16000
    ds_read_b128 v[44:47], v3 offset:16576
    s_mov_b64 exec, -1
    v_exp_f32 v84, v84
    v_exp_f32 v85, v85
    v_exp_f32 v86, v86
    v_exp_f32 v87, v87
    v_smfmac_f32_32x32x32_bf16 v[48:63], v[32:35], v[64:71], v4
    v_exp_f32 v88, v88
    v_exp_f32 v89, v89
    v_exp_f32 v90, v90
    v_exp_f32 v91, v91
    v_smfmac_f32_32x32x32_bf16 v[48:63], v[36:39], v[72:79], v4
    v_exp_f32 v92, v92
    v_exp_f32 v93, v93
    v_exp_f32 v94, v94
    v_exp_f32 v95, v95
    s_cmp_eq_u32 s60, 0
    s_cbranch_scc1 Lb3_6
    s_add_u32 s78, s78, s73
    buffer_store_dwordx4 v[200:203], v6, s[12:15], s78 offen sc1
    s_add_u32 s79, s79, s73
    buffer_store_dwordx4 v[204:207], v6, s[12:15], s79 offen sc1
Lb3_6:
    s_waitcnt lgkmcnt(0)
    v_mfma_f32_32x32x16_bf16 v[112:127], v[20:23], v[8:11], v[128:143]
    ds_read_b64 v[16:17], v2 offset:19456
    ds_read_b64 v[18:19], v2 offset:23552
    ds_read_b64 v[24:25], v2 offset:27648
    v_exp_f32 v96, v96
    v_exp_f32 v97, v97
    v_exp_f32 v98, v98
    v_exp_f32 v99, v99
    v_mfma_f32_32x32x8_bf16 v[112:127], v[30:31], v[14:15], v[112:127]
    s_mov_b64 exec, s[20:21]
    ds_read_b128 v[32:35], v3 offset:17152
    ds_read_b128 v[36:39], v3 offset:17728
    s_mov_b64 exec, -1
    v_exp_f32 v100, v100
    v_exp_f32 v101, v101
    v_exp_f32 v102, v102
    v_exp_f32 v103, v103
    v_smfmac_f32_32x32x32_bf16 v[48:63], v[40:43], v[80:87], v4
    v_exp_f32 v104, v104
    v_exp_f32 v105, v105
    v_exp_f32 v106, v106
    v_exp_f32 v107, v107
    v_smfmac_f32_32x32x32_bf16 v[48:63], v[44:47], v[88:95], v4
    v_exp_f32 v108, v108
    v_exp_f32 v109, v109
    v_exp_f32 v110, v110
    v_exp_f32 v111, v111
    s_waitcnt lgkmcnt(0)
    v_mfma_f32_32x32x16_bf16 v[64:79], v[16:19], v[8:11], v[128:143]
    ds_read_b64 v[20:21], v2 offset:19712
    ds_read_b64 v[22:23], v2 offset:23808
    ds_read_b64 v[26:27], v2 offset:27904
    v_exp_f32 v112, v112
    v_exp_f32 v113, v113
    v_exp_f32 v114, v114
    v_exp_f32 v115, v115
    v_mfma_f32_32x32x8_bf16 v[64:79], v[24:25], v[12:13], v[64:79]
    s_mov_b64 exec, s[20:21]
    ds_read_b128 v[40:43], v3 offset:18304
    ds_read_b128 v[44:47], v3 offset:18880
    s_mov_b64 exec, -1
    v_exp_f32 v116, v116
    v_exp_f32 v117, v117
    v_exp_f32 v118, v118
    v_exp_f32 v119, v119
    v_smfmac_f32_32x32x32_bf16 v[48:63], v[32:35], v[96:103], v4
    v_add_u32 v2, 19456, v2
    v_add_u32 v3, 19456, v3
    v_exp_f32 v120, v120
    v_exp_f32 v121, v121
    v_exp_f32 v122, v122
    v_exp_f32 v123, v123
    v_smfmac_f32_32x32x32_bf16 v[48:63], v[36:39], v[104:111], v4
    v_exp_f32 v124, v124
    v_exp_f32 v125, v125
    v_exp_f32 v126, v126
    v_exp_f32 v127, v127
    s_mul_i32 s61, s50, 9
    s_add_u32 s62, s61, 8
    s_add_u32 s61, s61, s24
    s_mul_i32 s33, s61, 18432
    s_add_u32 s33, s33, 11534336
    s_mul_i32 s34, s62, 18432
    s_add_u32 s34, s34, 11534336
    s_lshl_b32 s35, s24, 11
    s_add_u32 s35, s35, s34
    s_add_u32 s34, s34, 16384
    s_mul_i32 s38, s51, 36864
    s_lshl_b32 s36, s61, 5
    s_add_u32 s36, s36, s38
    s_lshl_b32 s37, s62, 5
    s_add_u32 s37, s37, s38
    v_and_b32 v5, 15, v1
    v_mul_u32_u24 v5, 1152, v5
    v_lshrrev_b32 v236, 4, v1
    v_lshl_add_u32 v5, v236, 3, v5
    s_lshl3_add_u32 s42, s52, s24
    s_mul_i32 s42, s42, 36
    s_add_u32 s42, s42, s62
    s_lshl1_add_u32 s42, s42, s53
    s_lshl_b32 s42, s42, 10
    s_add_u32 s42, s42, 33550336
    v_mov_b32 v244, -1
    v_mov_b32 v245, -1
    v_mov_b32 v246, -1
    v_mov_b32 v247, -1
Lb4_0:
    s_waitcnt lgkmcnt(0)
    v_mfma_f32_32x32x16_bf16 v[80:95], v[20:23], v[8:11], v[128:143]
    ds_read_b64 v[16:17], v2 offset:512
    ds_read_b64 v[18:19], v2 offset:4608
    ds_read_b64 v[28:29], v2 offset:8704
    s_cbranch_vccz Lp400
    s_setprio 0
Lp400:
    v_exp_f32 v64, v64
    v_exp_f32 v65, v65
    v_exp_f32 v66, v66
    v_exp_f32 v67, v67
    v_mfma_f32_32x32x8_bf16 v[80:95], v[26:27], v[12:13], v[80:95]
    s_mov_b64 exec, s[20:21]
    ds_read_b128 v[32:35], v3 offset:10240
    ds_read_b128 v[36:39], v3 offset:10816
    s_mov_b64 exec, -1
    v_exp_f32 v68, v68
    v_exp_f32 v69, v69
    v_exp_f32 v70, v70
    v_exp_f32 v71, v71
    v_smfmac_f32_32x32x32_bf16 v[48:63], v[40:43], v[112:119], v4
    v_exp_f32 v72, v72
    v_exp_f32 v73, v73
    v_exp_f32 v74, v74
    v_exp_f32 v75, v75
    v_smfmac_f32_32x32x32_bf16 v[48:63], v[44:47], v[120:127], v4
    v_exp_f32 v76, v76
    v_exp_f32 v77, v77
    v_exp_f32 v78, v78
    v_exp_f32 v79, v79
    s_waitcnt lgkmcnt(0)
    v_mfma_f32_32x32x16_bf16 v[96:111], v[16:19], v[8:11], v[128:143]
    ds_read_b64 v[20:21], v2 offset:768
    ds_read_b64 v[22:23], v2 offset:4864
    ds_read_b64 v[30:31], v2 offset:8960
    v_exp_f32 v80, v80
    v_exp_f32 v81, v81
    v_exp_f32 v82, v82
    v_exp_f32 v83, v83
    v_mfma_f32_32x32x8_bf16 v[96:111], v[28:29], v[12:13], v[96:111]
    s_mov_b64 exec, s[20:21]
    ds_read_b128 v[40:43], v3 offset:11392
    ds_read_b128 v[44:47], v3 offset:11968
    s_mov_b64 exec, -1
    v_exp_f32 v84, v84
    v_exp_f32 v85, v85
    v_exp_f32 v86, v86
    v_exp_f32 v87, v87
    v_smfmac_f32_32x32x32_bf16 v[48:63], v[32:35], v[64:71], v4
    v_exp_f32 v88, v88
    v_exp_f32 v89, v89
    v_exp_f32 v90, v90
    v_exp_f32 v91, v91
    v_smfmac_f32_32x32x32_bf16 v[48:63], v[36:39], v[72:79], v4
    v_exp_f32 v92, v92
    v_exp_f32 v93, v93
    v_exp_f32 v94, v94
    v_exp_f32 v95, v95
    s_waitcnt vmcnt(0)
    s_barrier
    s_cmp_eq_u32 s24, 7
    s_cbranch_scc0 Lh41
    s_lshl_b32 s39, s3, 5
    s_add_u32 s39, s39, s59
    s_lshl_b32 s39, s39, 2
    s_add_u32 s39, s39, 54558720
    s_mov_b64 exec, 1
    v_mov_b32 v0, 1
    buffer_store_dword v0, off, s[12:15], s39 sc1
    s_mov_b64 exec, -1
Lh41:
    buffer_store_dwordx4 v[244:247], v7, s[12:15], s42 offen offset:0 sc1
Lb4_2:
    s_waitcnt lgkmcnt(0)
    v_mfma_f32_32x32x16_bf16 v[112:127], v[20:23], v[8:11], v[128:143]
    ds_read_b64 v[16:17], v2 offset:2048
    ds_read_b64 v[18:19], v2 offset:6144
    v_exp_f32 v96, v96
    v_exp_f32 v97, v97
    v_exp_f32 v98, v98
    v_exp_f32 v99, v99
    v_mfma_f32_32x32x8_bf16 v[112:127], v[30:31], v[12:13], v[112:127]
    s_mov_b64 exec, s[20:21]
    ds_read_b128 v[32:35], v3 offset:12544
    ds_read_b128 v[36:39], v3 offset:13120
    s_mov_b64 exec, -1
    v_exp_f32 v100, v100
    v_exp_f32 v101, v101
    v_exp_f32 v102, v102
    v_exp_f32 v103, v103
    v_smfmac_f32_32x32x32_bf16 v[48:63], v[40:43], v[80:87], v4
    v_exp_f32 v104, v104
    v_exp_f32 v105, v105
    v_exp_f32 v106, v106
    v_exp_f32 v107, v107
    v_smfmac_f32_32x32x32_bf16 v[48:63], v[44:47], v[88:95], v4
    v_exp_f32 v108, v108
    v_exp_f32 v109, v109
    v_exp_f32 v110, v110
    v_exp_f32 v111, v111
    s_waitcnt lgkmcnt(0)
    v_mfma_f32_32x32x16_bf16 v[64:79], v[16:19], v[8:11], v[128:143]
    ds_read_b64 v[20:21], v2 offset:2304
    ds_read_b64 v[22:23], v2 offset:6400
    v_exp_f32 v112, v112
    v_exp_f32 v113, v113
    v_exp_f32 v114, v114
    v_exp_f32 v115, v115
    v_mfma_f32_32x32x8_bf16 v[64:79], v[24:25], v[14:15], v[64:79]
    s_mov_b64 exec, s[20:21]
    ds_read_b128 v[40:43], v3 offset:13696
    ds_read_b128 v[44:47], v3 offset:14272
    s_mov_b64 exec, -1
    v_exp_f32 v116, v116
    v_exp_f32 v117, v117
    v_exp_f32 v118, v118
    v_exp_f32 v119, v119
    v_smfmac_f32_32x32x32_bf16 v[48:63], v[32:35], v[96:103], v4
    v_exp_f32 v120, v120
    v_exp_f32 v121, v121
    v_exp_f32 v122, v122
    v_exp_f32 v123, v123
    v_smfmac_f32_32x32x32_bf16 v[48:63], v[36:39], v[104:111], v4
    v_exp_f32 v124, v124
    v_exp_f32 v125, v125
    v_exp_f32 v126, v126
    v_exp_f32 v127, v127
    buffer_load_dwordx4 v[148:151], v7, s[12:15], s33 offen offset:0
    buffer_load_dwordx4 v[152:155], v7, s[12:15], s33 offen offset:1024
Lb4_4:
    s_waitcnt lgkmcnt(0)
    v_mfma_f32_32x32x16_bf16 v[80:95], v[20:23], v[8:11], v[128:143]
    ds_read_b64 v[16:17], v2 offset:2560
    ds_read_b64 v[18:19], v2 offset:6656
    v_exp_f32 v64, v64
    v_exp_f32 v65, v65
    v_exp_f32 v66, v66
    v_exp_f32 v67, v67
    v_mfma_f32_32x32x8_bf16 v[80:95], v[26:27], v[14:15], v[80:95]
    s_mov_b64 exec, s[20:21]
    ds_read_b128 v[32:35], v3 offset:14848
    ds_read_b128 v[36:39], v3 offset:15424
    s_mov_b64 exec, -1
    v_exp_f32 v68, v68
    v_exp_f32 v69, v69
    v_exp_f32 v70, v70
    v_exp_f32 v71, v71
    v_smfmac_f32_32x32x32_bf16 v[48:63], v[40:43], v[112:119], v4
    s_cbranch_vccz Lp442
    s_setprio 2
Lp442:
    v_exp_f32 v72, v72
    v_exp_f32 v73, v73
    v_exp_f32 v74, v74
    v_exp_f32 v75, v75
    v_smfmac_f32_32x32x32_bf16 v[48:63], v[44:47], v[120:127], v4
    v_exp_f32 v76, v76
    v_exp_f32 v77, v77
    v_exp_f32 v78, v78
    v_exp_f32 v79, v79
    s_waitcnt lgkmcnt(0)
    v_mfma_f32_32x32x16_bf16 v[96:111], v[16:19], v[8:11], v[128:143]
    ds_read_b64 v[20:21], v2 offset:2816
    ds_read_b64 v[22:23], v2 offset:6912
    v_exp_f32 v80, v80
    v_exp_f32 v81, v81
    v_exp_f32 v82, v82
    v_exp_f32 v83, v83
    v_mfma_f32_32x32x8_bf16 v[96:111], v[28:29], v[14:15], v[96:111]
    s_mov_b64 exec, s[20:21]
    ds_read_b128 v[40:43], v3 offset:16000
    ds_read_b128 v[44:47], v3 offset:16576
    s_mov_b64 exec, -1
    v_exp_f32 v84, v84
    v_exp_f32 v85, v85
    v_exp_f32 v86, v86
    v_exp_f32 v87, v87
    v_smfmac_f32_32x32x32_bf16 v[48:63], v[32:35], v[64:71], v4
    v_exp_f32 v88, v88
    v_exp_f32 v89, v89
    v_exp_f32 v90, v90
    v_exp_f32 v91, v91
    v_smfmac_f32_32x32x32_bf16 v[48:63], v[36:39], v[72:79], v4
    v_exp_f32 v92, v92
    v_exp_f32 v93, v93
    v_exp_f32 v94, v94
    v_exp_f32 v95, v95
    buffer_load_dwordx4 v[156:159], v7, s[12:15], s33 offen offset:2048
    buffer_load_dwordx4 v[160:163], v7, s[12:15], s33 offen offset:3072
    s_add_u32 s33, s33, 4096
    buffer_store_dwordx4 v[244:247], v7, s[12:15], s42 offen offset:2048 sc1
    s_add_u32 s42, s42, 4096
Lb4_6:
    s_waitcnt lgkmcnt(0)
    v_mfma_f32_32x32x16_bf16 v[112:127], v[20:23], v[8:11], v[128:143]
    ds_read_b64 v[16:17], v2 offset:19456
    ds_read_b64 v[18:19], v2 offset:23552
    ds_read_b64 v[24:25], v2 offset:27648
    v_exp_f32 v96, v96
    v_exp_f32 v97, v97
    v_exp_f32 v98, v98
    v_exp_f32 v99, v99
    v_mfma_f32_32x32x8_bf16 v[112:127], v[30:31], v[14:15], v[112:127]
    s_mov_b64 exec, s[20:21]
    ds_read_b128 v[32:35], v3 offset:17152
    ds_read_b128 v[36:39], v3 offset:17728
    s_mov_b64 exec, -1
    v_exp_f32 v100, v100
    v_exp_f32 v101, v101
    v_exp_f32 v102, v102
    v_exp_f32 v103, v103
    v_smfmac_f32_32x32x32_bf16 v[48:63], v[40:43], v[80:87], v4
    v_exp_f32 v104, v104
    v_exp_f32 v105, v105
    v_exp_f32 v106, v106
    v_exp_f32 v107, v107
    v_smfmac_f32_32x32x32_bf16 v[48:63], v[44:47], v[88:95], v4
    v_exp_f32 v108, v108
    v_exp_f32 v109, v109
    v_exp_f32 v110, v110
    v_exp_f32 v111, v111
    s_waitcnt lgkmcnt(0)
    v_mfma_f32_32x32x16_bf16 v[64:79], v[16:19], v[8:11], v[128:143]
    ds_read_b64 v[20:21], v2 offset:19712
    ds_read_b64 v[22:23], v2 offset:23808
    ds_read_b64 v[26:27], v2 offset:27904
    v_exp_f32 v112, v112
    v_exp_f32 v113, v113
    v_exp_f32 v114, v114
    v_exp_f32 v115, v115
    v_mfma_f32_32x32x8_bf16 v[64:79], v[24:25], v[12:13], v[64:79]
    s_mov_b64 exec, s[20:21]
    ds_read_b128 v[40:43], v3 offset:18304
    ds_read_b128 v[44:47], v3 offset:18880
    s_mov_b64 exec, -1
    v_exp_f32 v116, v116
    v_exp_f32 v117, v117
    v_exp_f32 v118, v118
    v_exp_f32 v119, v119
    v_smfmac_f32_32x32x32_bf16 v[48:63], v[32:35], v[96:103], v4
    v_add_u32 v2, 19456, v2
    v_add_u32 v3, 19456, v3
    v_exp_f32 v120, v120
    v_exp_f32 v121, v121
    v_exp_f32 v122, v122
    v_exp_f32 v123, v123
    v_smfmac_f32_32x32x32_bf16 v[48:63], v[36:39], v[104:111], v4
    v_exp_f32 v124, v124
    v_exp_f32 v125, v125
    v_exp_f32 v126, v126
    v_exp_f32 v127, v127
    buffer_load_dwordx4 v[164:167], v7, s[12:15], s33 offen offset:0
    buffer_load_dwordx4 v[168:171], v7, s[12:15], s33 offen offset:1024
Lb5_0:
    s_waitcnt lgkmcnt(0)
    v_mfma_f32_32x32x16_bf16 v[80:95], v[20:23], v[8:11], v[128:143]
    ds_read_b64 v[16:17], v2 offset:512
    ds_read_b64 v[18:19], v2 offset:4608
    ds_read_b64 v[28:29], v2 offset:8704
    s_cbranch_vccz Lp500
    s_setprio 0
Lp500:
    v_exp_f32 v64, v64
    v_exp_f32 v65, v65
    v_exp_f32 v66, v66
    v_exp_f32 v67, v67
    v_mfma_f32_32x32x8_bf16 v[80:95], v[26:27], v[12:13], v[80:95]
    s_mov_b64 exec, s[20:21]
    ds_read_b128 v[32:35], v3 offset:10240
    ds_read_b128 v[36:39], v3 offset:10816
    s_mov_b64 exec, -1
    v_exp_f32 v68, v68
    v_exp_f32 v69, v69
    v_exp_f32 v70, v70
    v_exp_f32 v71, v71
    v_smfmac_f32_32x32x32_bf16 v[48:63], v[40:43], v[112:119], v4
    v_exp_f32 v72, v72
    v_exp_f32 v73, v73
    v_exp_f32 v74, v74
    v_exp_f32 v75, v75
    v_smfmac_f32_32x32x32_bf16 v[48:63], v[44:47], v[120:127], v4
    v_exp_f32 v76, v76
    v_exp_f32 v77, v77
    v_exp_f32 v78, v78
    v_exp_f32 v79, v79
    s_waitcnt lgkmcnt(0)
    v_mfma_f32_32x32x16_bf16 v[96:111], v[16:19], v[8:11], v[128:143]
    ds_read_b64 v[20:21], v2 offset:768
    ds_read_b64 v[22:23], v2 offset:4864
    ds_read_b64 v[30:31], v2 offset:8960
    v_exp_f32 v80, v80
    v_exp_f32 v81, v81
    v_exp_f32 v82, v82
    v_exp_f32 v83, v83
    v_mfma_f32_32x32x8_bf16 v[96:111], v[28:29], v[12:13], v[96:111]
    s_mov_b64 exec, s[20:21]
    ds_read_b128 v[40:43], v3 offset:11392
    ds_read_b128 v[44:47], v3 offset:11968
    s_mov_b64 exec, -1
    v_exp_f32 v84, v84
    v_exp_f32 v85, v85
    v_exp_f32 v86, v86
    v_exp_f32 v87, v87
    v_smfmac_f32_32x32x32_bf16 v[48:63], v[32:35], v[64:71], v4
    v_exp_f32 v88, v88
    v_exp_f32 v89, v89
    v_exp_f32 v90, v90
    v_exp_f32 v91, v91
    v_smfmac_f32_32x32x32_bf16 v[48:63], v[36:39], v[72:79], v4
    v_exp_f32 v92, v92
    v_exp_f32 v93, v93
    v_exp_f32 v94, v94
    v_exp_f32 v95, v95
    buffer_load_dwordx4 v[172:175], v7, s[12:15], s33 offen offset:2048
    buffer_load_dwordx4 v[176:179], v7, s[12:15], s33 offen offset:3072
    s_add_u32 s33, s33, 4096
    buffer_store_dwordx4 v[244:247], v7, s[12:15], s42 offen offset:0 sc1
Lb5_2:
    s_waitcnt lgkmcnt(0)
    v_mfma_f32_32x32x16_bf16 v[112:127], v[20:23], v[8:11], v[128:143]
    ds_read_b64 v[16:17], v2 offset:2048
    ds_read_b64 v[18:19], v2 offset:6144
    v_exp_f32 v96, v96
    v_exp_f32 v97, v97
    v_exp_f32 v98, v98
    v_exp_f32 v99, v99
    v_mfma_f32_32x32x8_bf16 v[112:127], v[30:31], v[12:13], v[112:127]
    s_mov_b64 exec, s[20:21]
    ds_read_b128 v[32:35], v3 offset:12544
    ds_read_b128 v[36:39], v3 offset:13120
    s_mov_b64 exec, -1
    v_exp_f32 v100, v100
    v_exp_f32 v101, v101
    v_exp_f32 v102, v102
    v_exp_f32 v103, v103
    v_smfmac_f32_32x32x32_bf16 v[48:63], v[40:43], v[80:87], v4
    v_exp_f32 v104, v104
    v_exp_f32 v105, v105
    v_exp_f32 v106, v106
    v_exp_f32 v107, v107
    v_smfmac_f32_32x32x32_bf16 v[48:63], v[44:47], v[88:95], v4
    v_exp_f32 v108, v108
    v_exp_f32 v109, v109
    v_exp_f32 v110, v110
    v_exp_f32 v111, v111
    s_waitcnt lgkmcnt(0)
    v_mfma_f32_32x32x16_bf16 v[64:79], v[16:19], v[8:11], v[128:143]
    ds_read_b64 v[20:21], v2 offset:2304
    ds_read_b64 v[22:23], v2 offset:6400
    v_exp_f32 v112, v112
    v_exp_f32 v113, v113
    v_exp_f32 v114, v114
    v_exp_f32 v115, v115
    v_mfma_f32_32x32x8_bf16 v[64:79], v[24:25], v[14:15], v[64:79]
    s_mov_b64 exec, s[20:21]
    ds_read_b128 v[40:43], v3 offset:13696
    ds_read_b128 v[44:47], v3 offset:14272
    s_mov_b64 exec, -1
    v_exp_f32 v116, v116
    v_exp_f32 v117, v117
    v_exp_f32 v118, v118
    v_exp_f32 v119, v119
    v_smfmac_f32_32x32x32_bf16 v[48:63], v[32:35], v[96:103], v4
    v_exp_f32 v120, v120
    v_exp_f32 v121, v121
    v_exp_f32 v122, v122
    v_exp_f32 v123, v123
    v_smfmac_f32_32x32x32_bf16 v[48:63], v[36:39], v[104:111], v4
    v_exp_f32 v124, v124
    v_exp_f32 v125, v125
    v_exp_f32 v126, v126
    v_exp_f32 v127, v127
    buffer_load_dwordx4 v[180:183], v7, s[12:15], s33 offen offset:0
    buffer_load_dwordx4 v[184:187], v7, s[12:15], s33 offen offset:1024
Lb5_4:
    s_waitcnt lgkmcnt(0)
    v_mfma_f32_32x32x16_bf16 v[80:95], v[20:23], v[8:11], v[128:143]
    ds_read_b64 v[16:17], v2 offset:2560
    ds_read_b64 v[18:19], v2 offset:6656
    v_exp_f32 v64, v64
    v_exp_f32 v65, v65
    v_exp_f32 v66, v66
    v_exp_f32 v67, v67
    v_mfma_f32_32x32x8_bf16 v[80:95], v[26:27], v[14:15], v[80:95]
    s_mov_b64 exec, s[20:21]
    ds_read_b128 v[32:35], v3 offset:14848
    ds_read_b128 v[36:39], v3 offset:15424
    s_mov_b64 exec, -1
    v_exp_f32 v68, v68
    v_exp_f32 v69, v69
    v_exp_f32 v70, v70
    v_exp_f32 v71, v71
    v_smfmac_f32_32x32x32_bf16 v[48:63], v[40:43], v[112:119], v4
    s_cbranch_vccz Lp542
    s_setprio 2
Lp542:
    v_exp_f32 v72, v72
    v_exp_f32 v73, v73
    v_exp_f32 v74, v74
    v_exp_f32 v75, v75
    v_smfmac_f32_32x32x32_bf16 v[48:63], v[44:47], v[120:127], v4
    v_exp_f32 v76, v76
    v_exp_f32 v77, v77
    v_exp_f32 v78, v78
    v_exp_f32 v79, v79
    s_waitcnt lgkmcnt(0)
    v_mfma_f32_32x32x16_bf16 v[96:111], v[16:19], v[8:11], v[128:143]
    ds_read_b64 v[20:21], v2 offset:2816
    ds_read_b64 v[22:23], v2 offset:6912
    v_exp_f32 v80, v80
    v_exp_f32 v81, v81
    v_exp_f32 v82, v82
    v_exp_f32 v83, v83
    v_mfma_f32_32x32x8_bf16 v[96:111], v[28:29], v[14:15], v[96:111]
    s_mov_b64 exec, s[20:21]
    ds_read_b128 v[40:43], v3 offset:16000
    ds_read_b128 v[44:47], v3 offset:16576
    s_mov_b64 exec, -1
    v_exp_f32 v84, v84
    v_exp_f32 v85, v85
    v_exp_f32 v86, v86
    v_exp_f32 v87, v87
    v_smfmac_f32_32x32x32_bf16 v[48:63], v[32:35], v[64:71], v4
    v_exp_f32 v88, v88
    v_exp_f32 v89, v89
    v_exp_f32 v90, v90
    v_exp_f32 v91, v91
    v_smfmac_f32_32x32x32_bf16 v[48:63], v[36:39], v[72:79], v4
    v_exp_f32 v92, v92
    v_exp_f32 v93, v93
    v_exp_f32 v94, v94
    v_exp_f32 v95, v95
    buffer_load_dwordx4 v[188:191], v7, s[12:15], s33 offen offset:2048
    buffer_load_dwordx4 v[192:195], v7, s[12:15], s33 offen offset:3072
    s_add_u32 s33, s33, 4096
    v_and_b32 v6, 31, v1
    v_lshlrev_b32 v6, 2, v6
    s_lshl_b32 s40, s3, 7
    s_add_u32 s40, s40, 54558720
    buffer_load_dword v144, v6, s[12:15], s40 offen sc1
Lb5_6:
    s_waitcnt lgkmcnt(0)
    v_mfma_f32_32x32x16_bf16 v[112:127], v[20:23], v[8:11], v[128:143]
    ds_read_b64 v[16:17], v2 offset:19456
    ds_read_b64 v[18:19], v2 offset:23552
    ds_read_b64 v[24:25], v2 offset:27648
    v_exp_f32 v96, v96
    v_exp_f32 v97, v97
    v_exp_f32 v98, v98
    v_exp_f32 v99, v99
    v_mfma_f32_32x32x8_bf16 v[112:127], v[30:31], v[14:15], v[112:127]
    s_mov_b64 exec, s[20:21]
    ds_read_b128 v[32:35], v3 offset:17152
    ds_read_b128 v[36:39], v3 offset:17728
    s_mov_b64 exec, -1
    v_exp_f32 v100, v100
    v_exp_f32 v101, v101
    v_exp_f32 v102, v102
    v_exp_f32 v103, v103
    v_smfmac_f32_32x32x32_bf16 v[48:63], v[40:43], v[80:87], v4
    v_exp_f32 v104, v104
    v_exp_f32 v105, v105
    v_exp_f32 v106, v106
    v_exp_f32 v107, v107
    v_smfmac_f32_32x32x32_bf16 v[48:63], v[44:47], v[88:95], v4
    v_exp_f32 v108, v108
    v_exp_f32 v109, v109
    v_exp_f32 v110, v110
    v_exp_f32 v111, v111
    s_waitcnt lgkmcnt(0)
    v_mfma_f32_32x32x16_bf16 v[64:79], v[16:19], v[8:11], v[128:143]
    ds_read_b64 v[20:21], v2 offset:19712
    ds_read_b64 v[22:23], v2 offset:23808
    ds_read_b64 v[26:27], v2 offset:27904
    v_exp_f32 v112, v112
    v_exp_f32 v113, v113
    v_exp_f32 v114, v114
    v_exp_f32 v115, v115
    v_mfma_f32_32x32x8_bf16 v[64:79], v[24:25], v[12:13], v[64:79]
    s_mov_b64 exec, s[20:21]
    ds_read_b128 v[40:43], v3 offset:18304
    ds_read_b128 v[44:47], v3 offset:18880
    s_mov_b64 exec, -1
    v_exp_f32 v116, v116
    v_exp_f32 v117, v117
    v_exp_f32 v118, v118
    v_exp_f32 v119, v119
    v_smfmac_f32_32x32x32_bf16 v[48:63], v[32:35], v[96:103], v4
    v_add_u32 v2, 19456, v2
    v_add_u32 v3, 19456, v3
    v_exp_f32 v120, v120
    v_exp_f32 v121, v121
    v_exp_f32 v122, v122
    v_exp_f32 v123, v123
    v_smfmac_f32_32x32x32_bf16 v[48:63], v[36:39], v[104:111], v4
    v_exp_f32 v124, v124
    v_exp_f32 v125, v125
    v_exp_f32 v126, v126
    v_exp_f32 v127, v127
    s_mov_b64 s[44:45], vcc
    s_waitcnt vmcnt(0)
    s_mov_b32 s84, 0x4000
    s_branch LpS_c
LpS:
    buffer_load_dword v144, v6, s[12:15], s40 offen sc1
    s_waitcnt vmcnt(0)
LpS_c:
    v_cmp_ne_u32 vcc, 1, v144
    s_sub_u32 s84, s84, 1
    s_cbranch_scc1 LpS_x
    s_cbranch_vccnz LpS
LpS_x:
    s_mov_b64 vcc, s[44:45]
    s_lshl_b32 s41, s59, 3
    s_add_u32 s41, s41, s24
    s_mul_i32 s41, s41, 5184
    s_mul_i32 s40, s3, 1327104
    s_add_u32 s40, s40, s41
    s_add_u32 s40, s40, 16777216
    v_lshlrev_b32 v6, 6, v1
    buffer_load_dword v144, v6, s[12:15], s40 offen
    buffer_load_dword v145, v6, s[12:15], s40 offen offset:1088
    buffer_load_dwordx4 v[196:199], v7, s[12:15], s33 offen offset:0
    buffer_load_dwordx4 v[200:203], v7, s[12:15], s33 offen offset:1024
Lb6_0:
    s_waitcnt lgkmcnt(0)
    v_mfma_f32_32x32x16_bf16 v[80:95], v[20:23], v[8:11], v[128:143]
    ds_read_b64 v[16:17], v2 offset:512
    ds_read_b64 v[18:19], v2 offset:4608
    ds_read_b64 v[28:29], v2 offset:8704
    s_cbranch_vccz Lp600
    s_setprio 0
Lp600:
    v_exp_f32 v64, v64
    v_exp_f32 v65, v65
    v_exp_f32 v66, v66
    v_exp_f32 v67, v67
    v_mfma_f32_32x32x8_bf16 v[80:95], v[26:27], v[12:13], v[80:95]
    s_mov_b64 exec, s[20:21]
    ds_read_b128 v[32:35], v3 offset:10240
    ds_read_b128 v[36:39], v3 offset:10816
    s_mov_b64 exec, -1
    v_exp_f32 v68, v68
    v_exp_f32 v69, v69
    v_exp_f32 v70, v70
    v_exp_f32 v71, v71
    v_smfmac_f32_32x32x32_bf16 v[48:63], v[40:43], v[112:119], v4
    v_exp_f32 v72, v72
    v_exp_f32 v73, v73
    v_exp_f32 v74, v74
    v_exp_f32 v75, v75
    v_smfmac_f32_32x32x32_bf16 v[48:63], v[44:47], v[120:127], v4
    v_exp_f32 v76, v76
    v_exp_f32 v77, v77
    v_exp_f32 v78, v78
    v_exp_f32 v79, v79
    s_waitcnt lgkmcnt(0)
    v_mfma_f32_32x32x16_bf16 v[96:111], v[16:19], v[8:11], v[128:143]
    ds_read_b64 v[20:21], v2 offset:768
    ds_read_b64 v[22:23], v2 offset:4864
    ds_read_b64 v[30:31], v2 offset:8960
    v_exp_f32 v80, v80
    v_exp_f32 v81, v81
    v_exp_f32 v82, v82
    v_exp_f32 v83, v83
    v_mfma_f32_32x32x8_bf16 v[96:111], v[28:29], v[12:13], v[96:111]
    s_mov_b64 exec, s[20:21]
    ds_read_b128 v[40:43], v3 offset:11392
    ds_read_b128 v[44:47], v3 offset:11968
    s_mov_b64 exec, -1
    v_exp_f32 v84, v84
    v_exp_f32 v85, v85
    v_exp_f32 v86, v86
    v_exp_f32 v87, v87
    v_smfmac_f32_32x32x32_bf16 v[48:63], v[32:35], v[64:71], v4
    v_exp_f32 v88, v88
    v_exp_f32 v89, v89
    v_exp_f32 v90, v90
    v_exp_f32 v91, v91
    v_smfmac_f32_32x32x32_bf16 v[48:63], v[36:39], v[72:79], v4
    v_exp_f32 v92, v92
    v_exp_f32 v93, v93
    v_exp_f32 v94, v94
    v_exp_f32 v95, v95
    buffer_load_dwordx4 v[204:207], v7, s[12:15], s33 offen offset:2048
    buffer_load_dwordx4 v[208:211], v7, s[12:15], s33 offen offset:3072
    s_add_u32 s33, s33, 4096
Lb6_2:
    s_waitcnt lgkmcnt(0)
    v_mfma_f32_32x32x16_bf16 v[112:127], v[20:23], v[8:11], v[128:143]
    ds_read_b64 v[16:17], v2 offset:2048
    ds_read_b64 v[18:19], v2 offset:6144
    v_exp_f32 v96, v96
    v_exp_f32 v97, v97
    v_exp_f32 v98, v98
    v_exp_f32 v99, v99
    v_mfma_f32_32x32x8_bf16 v[112:127], v[30:31], v[12:13], v[112:127]
    s_mov_b64 exec, s[20:21]
    ds_read_b128 v[32:35], v3 offset:12544
    ds_read_b128 v[36:39], v3 offset:13120
    s_mov_b64 exec, -1
    v_exp_f32 v100, v100
    v_exp_f32 v101, v101
    v_exp_f32 v102, v102
    v_exp_f32 v103, v103
    v_smfmac_f32_32x32x32_bf16 v[48:63], v[40:43], v[80:87], v4
    v_exp_f32 v104, v104
    v_exp_f32 v105, v105
    v_exp_f32 v106, v106
    v_exp_f32 v107, v107
    v_smfmac_f32_32x32x32_bf16 v[48:63], v[44:47], v[88:95], v4
    v_exp_f32 v108, v108
    v_exp_f32 v109, v109
    v_exp_f32 v110, v110
    v_exp_f32 v111, v111
    s_waitcnt lgkmcnt(0)
    v_mfma_f32_32x32x16_bf16 v[64:79], v[16:19], v[8:11], v[128:143]
    ds_read_b64 v[20:21], v2 offset:2304
    ds_read_b64 v[22:23], v2 offset:6400
    v_exp_f32 v112, v112
    v_exp_f32 v113, v113
    v_exp_f32 v114, v114
    v_exp_f32 v115, v115
    v_mfma_f32_32x32x8_bf16 v[64:79], v[24:25], v[14:15], v[64:79]
    s_mov_b64 exec, s[20:21]
    ds_read_b128 v[40:43], v3 offset:13696
    ds_read_b128 v[44:47], v3 offset:14272
    s_mov_b64 exec, -1
    v_exp_f32 v116, v116
    v_exp_f32 v117, v117
    v_exp_f32 v118, v118
    v_exp_f32 v119, v119
    v_smfmac_f32_32x32x32_bf16 v[48:63], v[32:35], v[96:103], v4
    v_exp_f32 v120, v120
    v_exp_f32 v121, v121
    v_exp_f32 v122, v122
    v_exp_f32 v123, v123
    v_smfmac_f32_32x32x32_bf16 v[48:63], v[36:39], v[104:111], v4
    v_exp_f32 v124, v124
    v_exp_f32 v125, v125
    v_exp_f32 v126, v126
    v_exp_f32 v127, v127
    buffer_load_dwordx4 v[212:215], v7, s[12:15], s33 offen offset:0
    buffer_load_dwordx4 v[216:219], v7, s[12:15], s33 offen offset:1024
Lb6_4:
    s_waitcnt lgkmcnt(0)
    v_mfma_f32_32x32x16_bf16 v[80:95], v[20:23], v[8:11], v[128:143]
    ds_read_b64 v[16:17], v2 offset:2560
    ds_read_b64 v[18:19], v2 offset:6656
    v_exp_f32 v64, v64
    v_exp_f32 v65, v65
    v_exp_f32 v66, v66
    v_exp_f32 v67, v67
    v_mfma_f32_32x32x8_bf16 v[80:95], v[26:27], v[14:15], v[80:95]
    s_mov_b64 exec, s[20:21]
    ds_read_b128 v[32:35], v3 offset:14848
    ds_read_b128 v[36:39], v3 offset:15424
    s_mov_b64 exec, -1
    v_exp_f32 v68, v68
    v_exp_f32 v69, v69
    v_exp_f32 v70, v70
    v_exp_f32 v71, v71
    v_smfmac_f32_32x32x32_bf16 v[48:63], v[40:43], v[112:119], v4
    s_cbranch_vccz Lp642
    s_setprio 2
Lp642:
    v_exp_f32 v72, v72
    v_exp_f32 v73, v73
    v_exp_f32 v74, v74
    v_exp_f32 v75, v75
    v_smfmac_f32_32x32x32_bf16 v[48:63], v[44:47], v[120:127], v4
    v_exp_f32 v76, v76
    v_exp_f32 v77, v77
    v_exp_f32 v78, v78
    v_exp_f32 v79, v79
    s_waitcnt lgkmcnt(0)
    v_mfma_f32_32x32x16_bf16 v[96:111], v[16:19], v[8:11], v[128:143]
    ds_read_b64 v[20:21], v2 offset:2816
    ds_read_b64 v[22:23], v2 offset:6912
    v_exp_f32 v80, v80
    v_exp_f32 v81, v81
    v_exp_f32 v82, v82
    v_exp_f32 v83, v83
    v_mfma_f32_32x32x8_bf16 v[96:111], v[28:29], v[14:15], v[96:111]
    s_mov_b64 exec, s[20:21]
    ds_read_b128 v[40:43], v3 offset:16000
    ds_read_b128 v[44:47], v3 offset:16576
    s_mov_b64 exec, -1
    v_exp_f32 v84, v84
    v_exp_f32 v85, v85
    v_exp_f32 v86, v86
    v_exp_f32 v87, v87
    v_smfmac_f32_32x32x32_bf16 v[48:63], v[32:35], v[64:71], v4
    v_exp_f32 v88, v88
    v_exp_f32 v89, v89
    v_exp_f32 v90, v90
    v_exp_f32 v91, v91
    v_smfmac_f32_32x32x32_bf16 v[48:63], v[36:39], v[72:79], v4
    v_exp_f32 v92, v92
    v_exp_f32 v93, v93
    v_exp_f32 v94, v94
    v_exp_f32 v95, v95
    buffer_load_dwordx4 v[220:223], v7, s[12:15], s35 offen offset:0
    buffer_load_dwordx4 v[224:227], v7, s[12:15], s35 offen offset:1024
Lb6_6:
    s_waitcnt lgkmcnt(0)
    v_mfma_f32_32x32x16_bf16 v[112:127], v[20:23], v[8:11], v[128:143]
    ds_read_b64 v[16:17], v2 offset:19456
    ds_read_b64 v[18:19], v2 offset:23552
    ds_read_b64 v[24:25], v2 offset:27648
    v_exp_f32 v96, v96
    v_exp_f32 v97, v97
    v_exp_f32 v98, v98
    v_exp_f32 v99, v99
    v_mfma_f32_32x32x8_bf16 v[112:127], v[30:31], v[14:15], v[112:127]
    s_mov_b64 exec, s[20:21]
    ds_read_b128 v[32:35], v3 offset:17152
    ds_read_b128 v[36:39], v3 offset:17728
    s_mov_b64 exec, -1
    v_exp_f32 v100, v100
    v_exp_f32 v101, v101
    v_exp_f32 v102, v102
    v_exp_f32 v103, v103
    v_smfmac_f32_32x32x32_bf16 v[48:63], v[40:43], v[80:87], v4
    v_exp_f32 v104, v104
    v_exp_f32 v105, v105
    v_exp_f32 v106, v106
    v_exp_f32 v107, v107
    v_smfmac_f32_32x32x32_bf16 v[48:63], v[44:47], v[88:95], v4
    v_exp_f32 v108, v108
    v_exp_f32 v109, v109
    v_exp_f32 v110, v110
    v_exp_f32 v111, v111
    s_waitcnt lgkmcnt(0)
    v_mfma_f32_32x32x16_bf16 v[64:79], v[16:19], v[8:11], v[128:143]
    ds_read_b64 v[20:21], v2 offset:19712
    ds_read_b64 v[22:23], v2 offset:23808
    ds_read_b64 v[26:27], v2 offset:27904
    v_exp_f32 v112, v112
    v_exp_f32 v113, v113
    v_exp_f32 v114, v114
    v_exp_f32 v115, v115
    v_mfma_f32_32x32x8_bf16 v[64:79], v[24:25], v[12:13], v[64:79]
    s_mov_b64 exec, s[20:21]
    ds_read_b128 v[40:43], v3 offset:18304
    ds_read_b128 v[44:47], v3 offset:18880
    s_mov_b64 exec, -1
    v_exp_f32 v116, v116
    v_exp_f32 v117, v117
    v_exp_f32 v118, v118
    v_exp_f32 v119, v119
    v_smfmac_f32_32x32x32_bf16 v[48:63], v[32:35], v[96:103], v4
    v_add_u32 v2, 19456, v2
    v_add_u32 v3, 19456, v3
    v_exp_f32 v120, v120
    v_exp_f32 v121, v121
    v_exp_f32 v122, v122
    v_exp_f32 v123, v123
    v_smfmac_f32_32x32x32_bf16 v[48:63], v[36:39], v[104:111], v4
    v_exp_f32 v124, v124
    v_exp_f32 v125, v125
    v_exp_f32 v126, v126
    v_exp_f32 v127, v127
    buffer_load_dwordx4 v[228:231], v7, s[12:15], s34 offen offset:0
    buffer_load_dwordx4 v[232:235], v7, s[12:15], s34 offen offset:1024
Lb7_0:
    s_waitcnt lgkmcnt(0)
    v_mfma_f32_32x32x16_bf16 v[80:95], v[20:23], v[8:11], v[128:143]
    ds_read_b64 v[16:17], v2 offset:512
    ds_read_b64 v[18:19], v2 offset:4608
    ds_read_b64 v[28:29], v2 offset:8704
    s_cbranch_vccz Lp700
    s_setprio 0
Lp700:
    v_exp_f32 v64, v64
    v_exp_f32 v65, v65
    v_exp_f32 v66, v66
    v_exp_f32 v67, v67
    v_mfma_f32_32x32x8_bf16 v[80:95], v[26:27], v[12:13], v[80:95]
    s_mov_b64 exec, s[20:21]
    ds_read_b128 v[32:35], v3 offset:10240
    ds_read_b128 v[36:39], v3 offset:10816
    s_mov_b64 exec, -1
    v_exp_f32 v68, v68
    v_exp_f32 v69, v69
    v_exp_f32 v70, v70
    v_exp_f32 v71, v71
    v_smfmac_f32_32x32x32_bf16 v[48:63], v[40:43], v[112:119], v4
    v_exp_f32 v72, v72
    v_exp_f32 v73, v73
    v_exp_f32 v74, v74
    v_exp_f32 v75, v75
    v_smfmac_f32_32x32x32_bf16 v[48:63], v[44:47], v[120:127], v4
    v_exp_f32 v76, v76
    v_exp_f32 v77, v77
    v_exp_f32 v78, v78
    v_exp_f32 v79, v79
    s_waitcnt lgkmcnt(0)
    v_mfma_f32_32x32x16_bf16 v[96:111], v[16:19], v[8:11], v[128:143]
    ds_read_b64 v[20:21], v2 offset:768
    ds_read_b64 v[22:23], v2 offset:4864
    ds_read_b64 v[30:31], v2 offset:8960
    v_exp_f32 v80, v80
    v_exp_f32 v81, v81
    v_exp_f32 v82, v82
    v_exp_f32 v83, v83
    v_mfma_f32_32x32x8_bf16 v[96:111], v[28:29], v[12:13], v[96:111]
    s_mov_b64 exec, s[20:21]
    ds_read_b128 v[40:43], v3 offset:11392
    ds_read_b128 v[44:47], v3 offset:11968
    s_mov_b64 exec, -1
    v_exp_f32 v84, v84
    v_exp_f32 v85, v85
    v_exp_f32 v86, v86
    v_exp_f32 v87, v87
    v_smfmac_f32_32x32x32_bf16 v[48:63], v[32:35], v[64:71], v4
    v_exp_f32 v88, v88
    v_exp_f32 v89, v89
    v_exp_f32 v90, v90
    v_exp_f32 v91, v91
    v_smfmac_f32_32x32x32_bf16 v[48:63], v[36:39], v[72:79], v4
    v_exp_f32 v92, v92
    v_exp_f32 v93, v93
    v_exp_f32 v94, v94
    v_exp_f32 v95, v95
    buffer_load_dwordx2 v[236:237], v5, s[16:19], s36 offen
    s_add_u32 s39, s36, 18432
    buffer_load_dwordx2 v[238:239], v5, s[16:19], s39 offen
    s_cmp_eq_u32 s24, 7
    s_cselect_b32 s18, s18, 0
    buffer_load_dwordx2 v[240:241], v5, s[16:19], s37 offen
    s_add_u32 s39, s37, 18432
    buffer_load_dwordx2 v[242:243], v5, s[16:19], s39 offen
Lb7_2:
    s_waitcnt lgkmcnt(0)
    v_mfma_f32_32x32x16_bf16 v[112:127], v[20:23], v[8:11], v[128:143]
    ds_read_b64 v[16:17], v2 offset:2048
    ds_read_b64 v[18:19], v2 offset:6144
    v_exp_f32 v96, v96
    v_exp_f32 v97, v97
    v_exp_f32 v98, v98
    v_exp_f32 v99, v99
    v_mfma_f32_32x32x8_bf16 v[112:127], v[30:31], v[12:13], v[112:127]
    s_mov_b64 exec, s[20:21]
    ds_read_b128 v[32:35], v3 offset:12544
    ds_read_b128 v[36:39], v3 offset:13120
    s_mov_b64 exec, -1
    v_exp_f32 v100, v100
    v_exp_f32 v101, v101
    v_exp_f32 v102, v102
    v_exp_f32 v103, v103
    v_smfmac_f32_32x32x32_bf16 v[48:63], v[40:43], v[80:87], v4
    v_exp_f32 v104, v104
    v_exp_f32 v105, v105
    v_exp_f32 v106, v106
    v_exp_f32 v107, v107
    v_smfmac_f32_32x32x32_bf16 v[48:63], v[44:47], v[88:95], v4
    v_exp_f32 v108, v108
    v_exp_f32 v109, v109
    v_exp_f32 v110, v110
    v_exp_f32 v111, v111
    s_waitcnt lgkmcnt(0)
    v_mfma_f32_32x32x16_bf16 v[64:79], v[16:19], v[8:11], v[128:143]
    ds_read_b64 v[20:21], v2 offset:2304
    ds_read_b64 v[22:23], v2 offset:6400
    v_exp_f32 v112, v112
    v_exp_f32 v113, v113
    v_exp_f32 v114, v114
    v_exp_f32 v115, v115
    v_mfma_f32_32x32x8_bf16 v[64:79], v[24:25], v[14:15], v[64:79]
    s_mov_b64 exec, s[20:21]
    ds_read_b128 v[40:43], v3 offset:13696
    ds_read_b128 v[44:47], v3 offset:14272
    s_mov_b64 exec, -1
    v_exp_f32 v116, v116
    v_exp_f32 v117, v117
    v_exp_f32 v118, v118
    v_exp_f32 v119, v119
    v_smfmac_f32_32x32x32_bf16 v[48:63], v[32:35], v[96:103], v4
    v_exp_f32 v120, v120
    v_exp_f32 v121, v121
    v_exp_f32 v122, v122
    v_exp_f32 v123, v123
    v_smfmac_f32_32x32x32_bf16 v[48:63], v[36:39], v[104:111], v4
    v_exp_f32 v124, v124
    v_exp_f32 v125, v125
    v_exp_f32 v126, v126
    v_exp_f32 v127, v127
Lb7_4:
    s_waitcnt lgkmcnt(0)
    v_mfma_f32_32x32x16_bf16 v[80:95], v[20:23], v[8:11], v[128:143]
    ds_read_b64 v[16:17], v2 offset:2560
    ds_read_b64 v[18:19], v2 offset:6656
    v_exp_f32 v64, v64
    v_exp_f32 v65, v65
    v_exp_f32 v66, v66
    v_exp_f32 v67, v67
    v_mfma_f32_32x32x8_bf16 v[80:95], v[26:27], v[14:15], v[80:95]
    s_mov_b64 exec, s[20:21]
    ds_read_b128 v[32:35], v3 offset:14848
    ds_read_b128 v[36:39], v3 offset:15424
    s_mov_b64 exec, -1
    v_exp_f32 v68, v68
    v_exp_f32 v69, v69
    v_exp_f32 v70, v70
    v_exp_f32 v71, v71
    v_smfmac_f32_32x32x32_bf16 v[48:63], v[40:43], v[112:119], v4
    s_cbranch_vccz Lp742
    s_setprio 2
Lp742:
    v_exp_f32 v72, v72
    v_exp_f32 v73, v73
    v_exp_f32 v74, v74
    v_exp_f32 v75, v75
    v_smfmac_f32_32x32x32_bf16 v[48:63], v[44:47], v[120:127], v4
    v_exp_f32 v76, v76
    v_exp_f32 v77, v77
    v_exp_f32 v78, v78
    v_exp_f32 v79, v79
    s_waitcnt lgkmcnt(0)
    v_mfma_f32_32x32x16_bf16 v[96:111], v[16:19], v[8:11], v[128:143]
    ds_read_b64 v[20:21], v2 offset:2816
    ds_read_b64 v[22:23], v2 offset:6912
    v_exp_f32 v80, v80
    v_exp_f32 v81, v81
    v_exp_f32 v82, v82
    v_exp_f32 v83, v83
    v_mfma_f32_32x32x8_bf16 v[96:111], v[28:29], v[14:15], v[96:111]
    s_mov_b64 exec, s[20:21]
    ds_read_b128 v[40:43], v3 offset:16000
    ds_read_b128 v[44:47], v3 offset:16576
    s_mov_b64 exec, -1
    v_exp_f32 v84, v84
    v_exp_f32 v85, v85
    v_exp_f32 v86, v86
    v_exp_f32 v87, v87
    v_smfmac_f32_32x32x32_bf16 v[48:63], v[32:35], v[64:71], v4
    v_exp_f32 v88, v88
    v_exp_f32 v89, v89
    v_exp_f32 v90, v90
    v_exp_f32 v91, v91
    v_smfmac_f32_32x32x32_bf16 v[48:63], v[36:39], v[72:79], v4
    v_exp_f32 v92, v92
    v_exp_f32 v93, v93
    v_exp_f32 v94, v94
    v_exp_f32 v95, v95
Lb7_6:
    s_waitcnt lgkmcnt(0)
    v_mfma_f32_32x32x16_bf16 v[112:127], v[20:23], v[8:11], v[128:143]
    ds_read_b64 v[16:17], v2 offset:19456
    ds_read_b64 v[18:19], v2 offset:23552
    ds_read_b64 v[24:25], v2 offset:27648
    v_exp_f32 v96, v96
    v_exp_f32 v97, v97
    v_exp_f32 v98, v98
    v_exp_f32 v99, v99
    v_mfma_f32_32x32x8_bf16 v[112:127], v[30:31], v[14:15], v[112:127]
    s_mov_b64 exec, s[20:21]
    ds_read_b128 v[32:35], v3 offset:17152
    ds_read_b128 v[36:39], v3 offset:17728
    s_mov_b64 exec, -1
    v_exp_f32 v100, v100
    v_exp_f32 v101, v101
    v_exp_f32 v102, v102
    v_exp_f32 v103, v103
    v_smfmac_f32_32x32x32_bf16 v[48:63], v[40:43], v[80:87], v4
    v_exp_f32 v104, v104
    v_exp_f32 v105, v105
    v_exp_f32 v106, v106
    v_exp_f32 v107, v107
    v_smfmac_f32_32x32x32_bf16 v[48:63], v[44:47], v[88:95], v4
    v_exp_f32 v108, v108
    v_exp_f32 v109, v109
    v_exp_f32 v110, v110
    v_exp_f32 v111, v111
    s_waitcnt lgkmcnt(0)
    v_mfma_f32_32x32x16_bf16 v[64:79], v[16:19], v[8:11], v[128:143]
    ds_read_b64 v[20:21], v2 offset:19712
    ds_read_b64 v[22:23], v2 offset:23808
    ds_read_b64 v[26:27], v2 offset:27904
    v_exp_f32 v112, v112
    v_exp_f32 v113, v113
    v_exp_f32 v114, v114
    v_exp_f32 v115, v115
    v_mfma_f32_32x32x8_bf16 v[64:79], v[24:25], v[12:13], v[64:79]
    s_mov_b64 exec, s[20:21]
    ds_read_b128 v[40:43], v3 offset:18304
    ds_read_b128 v[44:47], v3 offset:18880
    s_mov_b64 exec, -1
    v_exp_f32 v116, v116
    v_exp_f32 v117, v117
    v_exp_f32 v118, v118
    v_exp_f32 v119, v119
    v_smfmac_f32_32x32x32_bf16 v[48:63], v[32:35], v[96:103], v4
    v_add_u32 v2, 19456, v2
    v_add_u32 v3, 19456, v3
    v_exp_f32 v120, v120
    v_exp_f32 v121, v121
    v_exp_f32 v122, v122
    v_exp_f32 v123, v123
    v_smfmac_f32_32x32x32_bf16 v[48:63], v[36:39], v[104:111], v4
    v_exp_f32 v124, v124
    v_exp_f32 v125, v125
    v_exp_f32 v126, v126
    v_exp_f32 v127, v127
Lpost:
    s_waitcnt lgkmcnt(0)
    v_smfmac_f32_32x32x32_bf16 v[48:63], v[40:43], v[112:119], v4
    v_smfmac_f32_32x32x32_bf16 v[48:63], v[44:47], v[120:127], v4
    v_and_b32 v5, 15, v1
    v_lshrrev_b32 v6, 5, v1
    v_lshlrev_b32 v6, 8, v6
    v_lshl_add_u32 v6, v5, 4, v6
    v_bfe_u32 v5, v1, 4, 1
    v_lshl_add_u32 v6, v5, 9, v6
    v_and_b32 v5, 31, v1
    v_lshlrev_b32 v5, 2, v5
    s_mul_i32 s30, s28, 36864
    s_mul_i32 s31, s25, 1152
    s_add_u32 s30, s30, s31
    s_add_u32 s30, s30, 8388608
    s_mov_b32 s32, 0x1f800000
    s_mov_b32 s33, 0x5f800000
    s_cmp_gt_u32 s22, 8
    s_cbranch_scc1 Lfin
    v_cmp_le_f32 vcc, s32, v58
    v_cmp_ge_f32 s[34:35], s33, v58
    s_nop 0
    s_and_b64 vcc, vcc, s[34:35]
    s_cmp_eq_u64 vcc, -1
    s_cbranch_scc0 Lslow
Lfin:
    v_rcp_f32 v58, v58
    s_nop 0
    v_mul_f32 v48, v48, v58
    v_mul_f32 v49, v49, v58
    v_mul_f32 v50, v50, v58
    v_mul_f32 v51, v51, v58
    v_mul_f32 v52, v52, v58
    v_mul_f32 v53, v53, v58
    v_mul_f32 v54, v54, v58
    v_mul_f32 v55, v55, v58
    v_mul_f32 v56, v56, v58
    v_mul_f32 v57, v57, v58
    v_cvt_pk_bf16_f32 v48, v48, v49
    v_cvt_pk_bf16_f32 v49, v50, v51
    v_cvt_pk_bf16_f32 v50, v52, v53
    v_cvt_pk_bf16_f32 v51, v54, v55
    v_cvt_pk_bf16_f32 v52, v56, v57
    buffer_store_dwordx4 v[48:51], v6, s[12:15], s30 offen sc1
    s_mov_b32 exec_hi, 0
    buffer_store_dword v52, v5, s[12:15], s30 offen offset:1024 sc1
    s_mov_b32 exec_hi, -1
    s_lshl_b32 s32, s28, 9
    s_add_u32 s32, s32, s25
    s_lshl_b32 s32, s32, 1
    s_add_u32 s32, s32, 54559936
    v_lshlrev_b32 v9, 9, v1
    s_lshl_b32 s32, s28, 11
    s_lshr_b32 s33, s25, 3
    s_mul_i32 s33, s33, 112
    s_lshl1_add_u32 s33, s25, s33
    s_add_u32 s32, s32, s33
    s_add_u32 s32, s32, 54690816
    v_mov_b32 v0, 1
    s_mul_i32 s42, s3, 1327104
    s_mul_i32 s33, s24, 55296
    s_add_u32 s42, s42, s33
    s_add_u32 s42, s42, 16777216
    s_lshr_b32 s41, s24, 2
    s_and_b32 s43, s24, 3
    s_mov_b32 s38, 0xffff0000
    v_lshrrev_b32 v8, 4, v1
    v_and_b32 v10, 15, v1
    v_mul_u32_u24 v4, 1152, v8
    v_lshl_add_u32 v4, v10, 2, v4
    v_add_u32 v4, 1024, v4
    v_lshrrev_b32 v2, 5, v1
    v_mul_u32_u24 v2, 640, v2
    v_add_u32 v2, v2, v7
    s_mul_i32 s33, s24, 4608
    v_add_u32 v3, s33, v2
    s_mov_b32 s16, s8
    s_mov_b32 s17, s9
    s_mov_b32 s18, 0x4000000
    s_mov_b32 s19, 0x20000
    s_mov_b32 s20, s6
    s_mov_b32 s21, s7
    s_mov_b32 s22, 0x2400
    s_mov_b32 s23, 0x20000
    s_mov_b64 exec, 15
    s_waitcnt vmcnt(0)
    buffer_store_short v0, v9, s[12:15], s32 offen sc1
    s_mov_b64 exec, -1
    v_add_u32 v6, 64, v4
    v_lshlrev_b32 v244, 16, v236
    v_and_b32 v245, s38, v236
    v_lshlrev_b32 v246, 16, v237
    v_and_b32 v247, s38, v237
    v_lshlrev_b32 v248, 16, v238
    v_and_b32 v249, s38, v238
    v_lshlrev_b32 v250, 16, v239
    v_and_b32 v251, s38, v239
    v_lshlrev_b32 v140, 16, v240
    v_and_b32 v141, s38, v240
    v_lshlrev_b32 v142, 16, v241
    v_and_b32 v143, s38, v241
    v_lshlrev_b32 v144, 16, v242
    v_and_b32 v145, s38, v242
    v_lshlrev_b32 v146, 16, v243
    v_and_b32 v147, s38, v243
    s_cmp_eq_u32 s41, 0
    s_cbranch_scc0 LwB
    buffer_load_dwordx4 v[16:19], v7, s[16:19], s42 offen offset:0
    buffer_load_dwordx4 v[20:23], v7, s[16:19], s42 offen offset:1024
    buffer_load_dwordx4 v[24:27], v7, s[16:19], s42 offen offset:2048
    s_add_u32 s42, s42, 3072
    buffer_load_dwordx4 v[28:31], v7, s[16:19], s42 offen offset:0
    buffer_load_dwordx4 v[32:35], v7, s[16:19], s42 offen offset:1024
    buffer_load_dwordx4 v[36:39], v7, s[16:19], s42 offen offset:2048
    s_add_u32 s42, s42, 3072
    buffer_load_dwordx4 v[40:43], v7, s[16:19], s42 offen offset:0
    buffer_load_dwordx4 v[44:47], v7, s[16:19], s42 offen offset:1024
    buffer_load_dwordx4 v[48:51], v7, s[16:19], s42 offen offset:2048
    s_add_u32 s42, s42, 3072
    buffer_load_dwordx4 v[52:55], v7, s[16:19], s42 offen offset:0
    buffer_load_dwordx4 v[56:59], v7, s[16:19], s42 offen offset:1024
    buffer_load_dwordx4 v[60:63], v7, s[16:19], s42 offen offset:2048
    s_add_u32 s42, s42, 3072
    buffer_load_dwordx4 v[64:67], v7, s[16:19], s42 offen offset:0
    buffer_load_dwordx4 v[68:71], v7, s[16:19], s42 offen offset:1024
    buffer_load_dwordx4 v[72:75], v7, s[16:19], s42 offen offset:2048
    s_add_u32 s42, s42, 3072
    buffer_load_dwordx4 v[76:79], v7, s[16:19], s42 offen offset:0
    buffer_load_dwordx4 v[80:83], v7, s[16:19], s42 offen offset:1024
    buffer_load_dwordx4 v[84:87], v7, s[16:19], s42 offen offset:2048
    s_add_u32 s42, s42, 3072
    buffer_load_dwordx4 v[88:91], v7, s[16:19], s42 offen offset:0
    buffer_load_dwordx4 v[92:95], v7, s[16:19], s42 offen offset:1024
    buffer_load_dwordx4 v[96:99], v7, s[16:19], s42 offen offset:2048
    s_add_u32 s42, s42, 3072
    buffer_load_dwordx4 v[100:103], v7, s[16:19], s42 offen offset:0
    buffer_load_dwordx4 v[104:107], v7, s[16:19], s42 offen offset:1024
    buffer_load_dwordx4 v[108:111], v7, s[16:19], s42 offen offset:2048
    s_add_u32 s42, s42, 3072
    buffer_load_dwordx4 v[112:115], v7, s[16:19], s42 offen offset:0
    buffer_load_dwordx4 v[116:119], v7, s[16:19], s42 offen offset:1024
    buffer_load_dwordx4 v[120:123], v7, s[16:19], s42 offen offset:2048
    s_add_u32 s42, s42, 3072
    s_barrier
    s_branch Lw1
LwB:
    v_and_b32 v10, 7, v1
    v_lshlrev_b32 v10, 1, v10
    s_lshl_b32 s31, s51, 2
    s_add_u32 s31, s31, s43
    s_mul_i32 s32, s31, 9216
    s_add_u32 s32, s32, 8388608
    s_lshl2_add_u32 s31, s51, s50
    s_lshl2_add_u32 s31, s31, s43
    s_lshl_b32 s31, s31, 7
    s_add_u32 s31, s31, 54690816
    s_mul_i32 s33, s43, 9216
    s_mov_b32 m0, s33
    s_mov_b32 s84, 0x4000
Lp2:
    buffer_load_ushort v9, v10, s[12:15], s31 offen sc1
    s_waitcnt vmcnt(0)
Lp2_c:
    v_cmp_ne_u32 vcc, 1, v9
    s_sub_u32 s84, s84, 1
    s_cbranch_scc1 Lp2_x
    s_cbranch_vccnz Lp2
Lp2_x:
    s_barrier
    buffer_load_dwordx4 v7, s[12:15], s32 offen offset:0 sc1 lds
    buffer_load_dwordx4 v7, s[12:15], s32 offen offset:1024 sc1 lds
    buffer_load_dwordx4 v7, s[12:15], s32 offen offset:2048 sc1 lds
    s_add_u32 s32, s32, 3072
    s_add_u32 m0, m0, 3072
    s_nop 0
    buffer_load_dwordx4 v7, s[12:15], s32 offen offset:0 sc1 lds
    buffer_load_dwordx4 v7, s[12:15], s32 offen offset:1024 sc1 lds
    buffer_load_dwordx4 v7, s[12:15], s32 offen offset:2048 sc1 lds
    s_add_u32 s32, s32, 3072
    s_add_u32 m0, m0, 3072
    s_nop 0
    buffer_load_dwordx4 v7, s[12:15], s32 offen offset:0 sc1 lds
    buffer_load_dwordx4 v7, s[12:15], s32 offen offset:1024 sc1 lds
    buffer_load_dwordx4 v7, s[12:15], s32 offen offset:2048 sc1 lds
    buffer_load_dwordx4 v[16:19], v7, s[16:19], s42 offen offset:0
    buffer_load_dwordx4 v[20:23], v7, s[16:19], s42 offen offset:1024
    buffer_load_dwordx4 v[24:27], v7, s[16:19], s42 offen offset:2048
    s_add_u32 s42, s42, 3072
    buffer_load_dwordx4 v[28:31], v7, s[16:19], s42 offen offset:0
    buffer_load_dwordx4 v[32:35], v7, s[16:19], s42 offen offset:1024
    buffer_load_dwordx4 v[36:39], v7, s[16:19], s42 offen offset:2048
    s_add_u32 s42, s42, 3072
    buffer_load_dwordx4 v[40:43], v7, s[16:19], s42 offen offset:0
    buffer_load_dwordx4 v[44:47], v7, s[16:19], s42 offen offset:1024
    buffer_load_dwordx4 v[48:51], v7, s[16:19], s42 offen offset:2048
    s_add_u32 s42, s42, 3072
    s_waitcnt vmcnt(9)
Lw1:
    s_barrier
    ds_read_b128 v[124:127], v3 offset:0
    ds_read_b128 v[128:131], v3 offset:512
    ds_read_b128 v[132:135], v3 offset:2304
    ds_read_b128 v[136:139], v3 offset:2816
    ds_read_b128 v[8:11], v2 offset:0
    ds_read_b128 v[12:15], v2 offset:512
    s_lshl_b32 s33, s24, 11
    v_add_u32 v3, s33, v7
    s_waitcnt lgkmcnt(2)
    v_mfma_f32_16x16x32_bf16 v[140:143], v[220:223], v[124:127], v[140:143]
    v_mfma_f32_16x16x32_bf16 v[144:147], v[220:223], v[128:131], v[144:147]
    v_mfma_f32_16x16x32_bf16 v[140:143], v[224:227], v[132:135], v[140:143]
    v_mfma_f32_16x16x32_bf16 v[144:147], v[224:227], v[136:139], v[144:147]
    ds_read_b128 v[124:127], v2 offset:2304
    ds_read_b128 v[128:131], v2 offset:2816
    s_waitcnt lgkmcnt(2)
    v_mfma_f32_16x16x32_bf16 v[244:247], v[148:151], v[8:11], v[244:247]
    v_mfma_f32_16x16x32_bf16 v[248:251], v[148:151], v[12:15], v[248:251]
    ds_read_b128 v[132:135], v2 offset:4608
    ds_read_b128 v[136:139], v2 offset:5120
    s_waitcnt lgkmcnt(2)
    v_mfma_f32_16x16x32_bf16 v[244:247], v[152:155], v[124:127], v[244:247]
    v_mfma_f32_16x16x32_bf16 v[248:251], v[152:155], v[128:131], v[248:251]
    ds_read_b128 v[8:11], v2 offset:6912
    ds_read_b128 v[12:15], v2 offset:7424
    ds_write_b128 v3, v[140:143] offset:36864
    ds_write_b128 v3, v[144:147] offset:37888
    s_waitcnt lgkmcnt(2)
    v_mfma_f32_16x16x32_bf16 v[244:247], v[156:159], v[132:135], v[244:247]
    v_mfma_f32_16x16x32_bf16 v[248:251], v[156:159], v[136:139], v[248:251]
    ds_read_b128 v[124:127], v2 offset:9216
    ds_read_b128 v[128:131], v2 offset:9728
    s_waitcnt lgkmcnt(2)
    v_mfma_f32_16x16x32_bf16 v[244:247], v[160:163], v[8:11], v[244:247]
    v_mfma_f32_16x16x32_bf16 v[248:251], v[160:163], v[12:15], v[248:251]
    ds_read_b128 v[132:135], v2 offset:11520
    ds_read_b128 v[136:139], v2 offset:12032
    s_waitcnt lgkmcnt(2)
    v_mfma_f32_16x16x32_bf16 v[244:247], v[164:167], v[124:127], v[244:247]
    v_mfma_f32_16x16x32_bf16 v[248:251], v[164:167], v[128:131], v[248:251]
    ds_read_b128 v[8:11], v2 offset:13824
    ds_read_b128 v[12:15], v2 offset:14336
    s_waitcnt lgkmcnt(2)
    s_barrier
    v_mfma_f32_16x16x32_bf16 v[244:247], v[168:171], v[132:135], v[244:247]
    v_mfma_f32_16x16x32_bf16 v[248:251], v[168:171], v[136:139], v[248:251]
    ds_read_b128 v[124:127], v2 offset:16128
    ds_read_b128 v[128:131], v2 offset:16640
    s_waitcnt lgkmcnt(2)
    v_mfma_f32_16x16x32_bf16 v[244:247], v[172:175], v[8:11], v[244:247]
    v_mfma_f32_16x16x32_bf16 v[248:251], v[172:175], v[12:15], v[248:251]
    ds_read_b128 v[132:135], v2 offset:18432
    ds_read_b128 v[136:139], v2 offset:18944
    s_waitcnt lgkmcnt(2)
    v_mfma_f32_16x16x32_bf16 v[244:247], v[176:179], v[124:127], v[244:247]
    v_mfma_f32_16x16x32_bf16 v[248:251], v[176:179], v[128:131], v[248:251]
    ds_read_b128 v[8:11], v2 offset:20736
    ds_read_b128 v[12:15], v2 offset:21248
    s_waitcnt lgkmcnt(2)
    v_mfma_f32_16x16x32_bf16 v[244:247], v[180:183], v[132:135], v[244:247]
    v_mfma_f32_16x16x32_bf16 v[248:251], v[180:183], v[136:139], v[248:251]
    ds_read_b128 v[124:127], v2 offset:23040
    ds_read_b128 v[128:131], v2 offset:23552
    s_cmp_eq_u32 s24, 7
    s_cbranch_scc0 Lw78
    ds_read_b128 v[148:151], v7 offset:36864
    ds_read_b128 v[152:155], v7 offset:38912
    ds_read_b128 v[156:159], v7 offset:40960
    ds_read_b128 v[160:163], v7 offset:43008
    ds_read_b128 v[164:167], v7 offset:45056
    ds_read_b128 v[168:171], v7 offset:47104
    ds_read_b128 v[172:175], v7 offset:49152
Lw78:
    s_waitcnt lgkmcnt(2)
    v_mfma_f32_16x16x32_bf16 v[244:247], v[184:187], v[8:11], v[244:247]
    v_mfma_f32_16x16x32_bf16 v[248:251], v[184:187], v[12:15], v[248:251]
    ds_read_b128 v[132:135], v2 offset:25344
    ds_read_b128 v[136:139], v2 offset:25856
    s_waitcnt lgkmcnt(2)
    v_mfma_f32_16x16x32_bf16 v[244:247], v[188:191], v[124:127], v[244:247]
    v_mfma_f32_16x16x32_bf16 v[248:251], v[188:191], v[128:131], v[248:251]
    ds_read_b128 v[8:11], v2 offset:27648
    ds_read_b128 v[12:15], v2 offset:28160
    s_waitcnt lgkmcnt(2)
    v_mfma_f32_16x16x32_bf16 v[244:247], v[192:195], v[132:135], v[244:247]
    v_mfma_f32_16x16x32_bf16 v[248:251], v[192:195], v[136:139], v[248:251]
    ds_read_b128 v[124:127], v2 offset:29952
    ds_read_b128 v[128:131], v2 offset:30464
    s_cmp_eq_u32 s24, 7
    s_cbranch_scc0 Lw711
    v_add_f32 v140, v140, v148
    v_add_f32 v141, v141, v149
    v_add_f32 v142, v142, v150
    v_add_f32 v143, v143, v151
    v_add_f32 v140, v140, v152
    v_add_f32 v141, v141, v153
    v_add_f32 v142, v142, v154
    v_add_f32 v143, v143, v155
    v_add_f32 v140, v140, v156
    v_add_f32 v141, v141, v157
    v_add_f32 v142, v142, v158
    v_add_f32 v143, v143, v159
    v_add_f32 v140, v140, v160
    v_add_f32 v141, v141, v161
    v_add_f32 v142, v142, v162
    v_add_f32 v143, v143, v163
    v_add_f32 v140, v140, v164
    v_add_f32 v141, v141, v165
    v_add_f32 v142, v142, v166
    v_add_f32 v143, v143, v167
    v_add_f32 v140, v140, v168
    v_add_f32 v141, v141, v169
    v_add_f32 v142, v142, v170
    v_add_f32 v143, v143, v171
    v_add_f32 v140, v140, v172
    v_add_f32 v141, v141, v173
    v_add_f32 v142, v142, v174
    v_add_f32 v143, v143, v175
    ds_read_b128 v[148:151], v7 offset:37888
    ds_read_b128 v[152:155], v7 offset:39936
    ds_read_b128 v[156:159], v7 offset:41984
    ds_read_b128 v[160:163], v7 offset:44032
    ds_read_b128 v[164:167], v7 offset:46080
    ds_read_b128 v[168:171], v7 offset:48128
    ds_read_b128 v[172:175], v7 offset:50176
Lw711:
    s_waitcnt lgkmcnt(2)
    v_mfma_f32_16x16x32_bf16 v[244:247], v[196:199], v[8:11], v[244:247]
    v_mfma_f32_16x16x32_bf16 v[248:251], v[196:199], v[12:15], v[248:251]
    ds_read_b128 v[132:135], v2 offset:32256
    ds_read_b128 v[136:139], v2 offset:32768
    s_waitcnt lgkmcnt(2)
    v_mfma_f32_16x16x32_bf16 v[244:247], v[200:203], v[124:127], v[244:247]
    v_mfma_f32_16x16x32_bf16 v[248:251], v[200:203], v[128:131], v[248:251]
    ds_read_b128 v[8:11], v2 offset:34560
    ds_read_b128 v[12:15], v2 offset:35072
    s_waitcnt lgkmcnt(2)
    v_mfma_f32_16x16x32_bf16 v[244:247], v[204:207], v[132:135], v[244:247]
    v_mfma_f32_16x16x32_bf16 v[248:251], v[204:207], v[136:139], v[248:251]
    ds_read2st64_b32 v[124:125], v4 offset0:0 offset1:18
    ds_read2st64_b32 v[126:127], v4 offset0:36 offset1:54
    ds_read2st64_b32 v[128:129], v6 offset0:0 offset1:18
    ds_read2st64_b32 v[130:131], v6 offset0:36 offset1:54
    s_cmp_eq_u32 s24, 7
    s_cbranch_scc0 Lw714
    v_add_f32 v144, v144, v148
    v_add_f32 v145, v145, v149
    v_add_f32 v146, v146, v150
    v_add_f32 v147, v147, v151
    v_add_f32 v144, v144, v152
    v_add_f32 v145, v145, v153
    v_add_f32 v146, v146, v154
    v_add_f32 v147, v147, v155
    v_add_f32 v144, v144, v156
    v_add_f32 v145, v145, v157
    v_add_f32 v146, v146, v158
    v_add_f32 v147, v147, v159
    v_add_f32 v144, v144, v160
    v_add_f32 v145, v145, v161
    v_add_f32 v146, v146, v162
    v_add_f32 v147, v147, v163
    v_add_f32 v144, v144, v164
    v_add_f32 v145, v145, v165
    v_add_f32 v146, v146, v166
    v_add_f32 v147, v147, v167
    v_add_f32 v144, v144, v168
    v_add_f32 v145, v145, v169
    v_add_f32 v146, v146, v170
    v_add_f32 v147, v147, v171
    v_add_f32 v144, v144, v172
    v_add_f32 v145, v145, v173
    v_add_f32 v146, v146, v174
    v_add_f32 v147, v147, v175
Lw714:
    s_waitcnt lgkmcnt(4)
    v_mfma_f32_16x16x32_bf16 v[244:247], v[208:211], v[8:11], v[244:247]
    v_mfma_f32_16x16x32_bf16 v[248:251], v[208:211], v[12:15], v[248:251]
    ds_read2st64_b32 v[132:133], v4 offset0:72 offset1:90
    ds_read2st64_b32 v[134:135], v4 offset0:108 offset1:126
    ds_read2st64_b32 v[136:137], v6 offset0:72 offset1:90
    ds_read2st64_b32 v[138:139], v6 offset0:108 offset1:126
    s_waitcnt lgkmcnt(4)
    v_mfma_f32_16x16x32_bf16 v[244:247], v[212:215], v[124:127], v[244:247]
    v_mfma_f32_16x16x32_bf16 v[248:251], v[212:215], v[128:131], v[248:251]
    s_waitcnt lgkmcnt(0)
    v_mfma_f32_16x16x32_bf16 v[244:247], v[216:219], v[132:135], v[244:247]
    v_mfma_f32_16x16x32_bf16 v[248:251], v[216:219], v[136:139], v[248:251]
    s_cmp_eq_u32 s24, 7
    s_cbranch_scc0 Lw717
    v_mfma_f32_16x16x32_bf16 v[140:143], v[228:231], v[124:127], v[140:143]
    v_mfma_f32_16x16x32_bf16 v[144:147], v[228:231], v[128:131], v[144:147]
    v_mfma_f32_16x16x32_bf16 v[140:143], v[232:235], v[132:135], v[140:143]
    v_mfma_f32_16x16x32_bf16 v[144:147], v[232:235], v[136:139], v[144:147]
Lw717:
    v_bfe_u32 v2, v1, 4, 1
    v_and_b32 v3, 15, v1
    v_lshlrev_b32 v3, 4, v3
    v_lshl_add_u32 v2, v2, 10, v3
    v_lshrrev_b32 v3, 5, v1
    v_lshl_add_u32 v2, v3, 8, v2
    s_mul_i32 s27, s59, 73728
    s_add_u32 s27, s27, 12582912
    s_mul_i32 s33, s52, 73728
    s_lshl_b32 s31, s53, 11
    s_add_u32 s31, s31, s33
    s_add_u32 s31, s31, 12582912
    s_lshl_b32 s33, s24, 10
    s_add_u32 s33, s33, 147456
    v_add_u32 v3, s33, v7
    s_lshr_b32 s32, s61, 1
    s_mul_i32 s32, s32, 3072
    s_lshl_b32 s33, s61, 9
    s_add_u32 s32, s32, s33
    s_add_u32 s32, s32, s31
    v_cvt_pk_bf16_f32 v12, v244, v245
    v_cvt_pk_bf16_f32 v13, v246, v247
    v_cvt_pk_bf16_f32 v14, v248, v249
    v_cvt_pk_bf16_f32 v15, v250, v251
    ds_write_b128 v3, v[12:15] offset:0
    s_nop 1
    v_permlane16_swap_b32 v12, v14
    v_permlane16_swap_b32 v13, v15
    buffer_store_dwordx4 v[12:15], v2, s[12:15], s32 offen sc1
    s_cmp_eq_u32 s24, 7
    s_cbranch_scc0 Lw2
    s_lshr_b32 s32, s62, 1
    s_mul_i32 s32, s32, 3072
    s_lshl_b32 s33, s62, 9
    s_add_u32 s32, s32, s33
    s_add_u32 s32, s32, s31
    v_cvt_pk_bf16_f32 v124, v140, v141
    v_cvt_pk_bf16_f32 v125, v142, v143
    v_cvt_pk_bf16_f32 v126, v144, v145
    v_cvt_pk_bf16_f32 v127, v146, v147
    ds_write_b128 v3, v[124:127] offset:1024
    s_nop 1
    v_permlane16_swap_b32 v124, v126
    v_permlane16_swap_b32 v125, v127
    buffer_store_dwordx4 v[124:127], v2, s[12:15], s32 offen sc1
Lw2:
    v_add_f32 v8, v244, v245
    v_mul_f32 v9, v244, v244
    v_add_f32 v10, v248, v249
    v_mul_f32 v11, v248, v248
    v_fmac_f32 v9, v245, v245
    v_fmac_f32 v11, v249, v249
    v_add_f32 v8, v8, v246
    v_fmac_f32 v9, v246, v246
    v_add_f32 v10, v10, v250
    v_fmac_f32 v11, v250, v250
    v_add_f32 v8, v8, v247
    v_fmac_f32 v9, v247, v247
    v_add_f32 v10, v10, v251
    v_fmac_f32 v11, v251, v251
    s_cmp_eq_u32 s24, 7
    s_cbranch_scc0 Lw2b
    v_add_f32 v8, v8, v140
    v_fmac_f32 v9, v140, v140
    v_add_f32 v10, v10, v144
    v_fmac_f32 v11, v144, v144
    v_add_f32 v8, v8, v141
    v_fmac_f32 v9, v141, v141
    v_add_f32 v10, v10, v145
    v_fmac_f32 v11, v145, v145
    v_add_f32 v8, v8, v142
    v_fmac_f32 v9, v142, v142
    v_add_f32 v10, v10, v146
    v_fmac_f32 v11, v146, v146
    v_add_f32 v8, v8, v143
    v_fmac_f32 v9, v143, v143
    v_add_f32 v10, v10, v147
    v_fmac_f32 v11, v147, v147
Lw2b:
    s_lshl_b32 s33, s24, 8
    s_add_u32 s33, s33, 73728
    v_lshl_add_u32 v3, v1, 2, s33
    v_permlane32_swap_b32 v8, v10
    v_permlane32_swap_b32 v9, v11
    v_add_f32 v8, v8, v10
    v_add_f32 v9, v9, v11
    s_nop 1
    v_permlane16_swap_b32 v8, v9
    v_add_f32 v8, v8, v9
    ds_write_b32 v3, v8
    v_lshrrev_b32 v11, 4, v1
    v_and_b32 v10, 15, v1
    v_lshlrev_b32 v10, 3, v10
    s_mul_i32 s28, s41, 384
    s_lshl1_add_u32 s28, s43, s28
    s_mul_i32 s29, s3, 1152
    s_add_u32 s34, s28, s29
    s_cmp_eq_u32 s41, 0
    s_cbranch_scc0 LfB
    s_lshl_b32 s32, s51, 2
    s_add_u32 s32, s32, s50
    s_lshl_b32 s32, s32, 8
    s_add_u32 s32, s32, 54625280
    v_lshrrev_b32 v2, 5, v1
    v_lshl_add_u32 v10, v2, 7, v10
    v_and_b32 v2, 1, v11
    v_lshl_add_u32 v10, v2, 2, v10
    s_cmp_eq_u32 s24, 0
    s_waitcnt vmcnt(0) lgkmcnt(0)
    s_barrier
    s_cmp_eq_u32 s24, 0
    s_cbranch_scc0 Lw5
    ds_read2st64_b32 v[148:149], v3 offset0:0 offset1:1
    ds_read2st64_b32 v[150:151], v3 offset0:2 offset1:3
    ds_read2st64_b32 v[152:153], v3 offset0:4 offset1:5
    ds_read2st64_b32 v[154:155], v3 offset0:6 offset1:7
    s_waitcnt lgkmcnt(0)
    v_add_f32 v148, v148, v152
    v_add_f32 v149, v149, v153
    v_add_f32 v150, v150, v154
    v_add_f32 v151, v151, v155
    v_add_f32 v148, v148, v150
    v_add_f32 v149, v149, v151
    v_add_f32 v148, v148, v149
    v_or_b32 v8, 1, v148
    buffer_store_dword v8, v10, s[12:15], s32 offen sc1
Lw5:
    v_mov_b32 v124, 0
    v_mov_b32 v125, 0
    v_mov_b32 v126, 0
    v_mov_b32 v127, 0
    v_mov_b32 v128, 0
    v_mov_b32 v129, 0
    v_mov_b32 v130, 0
    v_mov_b32 v131, 0
    v_mov_b32 v132, 0
    v_mov_b32 v133, 0
    v_mov_b32 v134, 0
    v_mov_b32 v135, 0
    v_mov_b32 v136, 0
    v_mov_b32 v137, 0
    v_mov_b32 v138, 0
    v_mov_b32 v139, 0
    v_mov_b32 v140, 0
    v_mov_b32 v141, 0
    v_mov_b32 v142, 0
    v_mov_b32 v143, 0
    v_mov_b32 v144, 0
    v_mov_b32 v145, 0
    v_mov_b32 v146, 0
    v_mov_b32 v147, 0
    v_lshlrev_b32 v11, 5, v11
    buffer_load_short_d16_hi v124, v11, s[20:23], s34 offen offset:0
    buffer_load_short_d16_hi v125, v11, s[20:23], s34 offen offset:8
    buffer_load_short_d16_hi v126, v11, s[20:23], s34 offen offset:16
    buffer_load_short_d16_hi v127, v11, s[20:23], s34 offen offset:24
    buffer_load_short_d16_hi v136, v11, s[20:23], s34 offen offset:768
    buffer_load_short_d16_hi v137, v11, s[20:23], s34 offen offset:776
    buffer_load_short_d16_hi v138, v11, s[20:23], s34 offen offset:784
    buffer_load_short_d16_hi v139, v11, s[20:23], s34 offen offset:792
    buffer_load_short_d16_hi v128, v11, s[20:23], s34 offen offset:128
    buffer_load_short_d16_hi v129, v11, s[20:23], s34 offen offset:136
    buffer_load_short_d16_hi v130, v11, s[20:23], s34 offen offset:144
    buffer_load_short_d16_hi v131, v11, s[20:23], s34 offen offset:152
    buffer_load_short_d16_hi v140, v11, s[20:23], s34 offen offset:896
    buffer_load_short_d16_hi v141, v11, s[20:23], s34 offen offset:904
    buffer_load_short_d16_hi v142, v11, s[20:23], s34 offen offset:912
    buffer_load_short_d16_hi v143, v11, s[20:23], s34 offen offset:920
    buffer_load_short_d16_hi v132, v11, s[20:23], s34 offen offset:256
    buffer_load_short_d16_hi v133, v11, s[20:23], s34 offen offset:264
    buffer_load_short_d16_hi v134, v11, s[20:23], s34 offen offset:272
    buffer_load_short_d16_hi v135, v11, s[20:23], s34 offen offset:280
    buffer_load_short_d16_hi v144, v11, s[20:23], s34 offen offset:1024
    buffer_load_short_d16_hi v145, v11, s[20:23], s34 offen offset:1032
    buffer_load_short_d16_hi v146, v11, s[20:23], s34 offen offset:1040
    buffer_load_short_d16_hi v147, v11, s[20:23], s34 offen offset:1048
    s_branch Lf0
LfB:
    buffer_load_dwordx4 v[52:55], v7, s[16:19], s42 offen offset:0
    buffer_load_dwordx4 v[56:59], v7, s[16:19], s42 offen offset:1024
    buffer_load_dwordx4 v[60:63], v7, s[16:19], s42 offen offset:2048
    s_add_u32 s42, s42, 3072
    buffer_load_dwordx4 v[64:67], v7, s[16:19], s42 offen offset:0
    buffer_load_dwordx4 v[68:71], v7, s[16:19], s42 offen offset:1024
    buffer_load_dwordx4 v[72:75], v7, s[16:19], s42 offen offset:2048
    s_add_u32 s42, s42, 3072
    buffer_load_dwordx4 v[76:79], v7, s[16:19], s42 offen offset:0
    buffer_load_dwordx4 v[80:83], v7, s[16:19], s42 offen offset:1024
    buffer_load_dwordx4 v[84:87], v7, s[16:19], s42 offen offset:2048
    s_add_u32 s42, s42, 3072
    v_lshl_add_u32 v10, v11, 8, v10
    s_lshl_b32 s31, s59, 11
    s_lshr_b32 s32, s43, 1
    s_mul_i32 s32, s32, 768
    s_add_u32 s31, s31, s32
    s_lshl_b32 s32, s43, 7
    s_add_u32 s31, s31, s32
    s_add_u32 s31, s31, 54625280
    s_and_b32 s32, s3, 0
    s_lshl_b32 s32, s32, 16
    s_add_u32 s31, s31, s32
    s_lshl_b32 s32, s43, 10
    v_add_u32 v2, s32, v7
    v_add_u32 v6, 36864, v2
    s_waitcnt vmcnt(9) lgkmcnt(0)
    s_barrier
    s_setprio 3
    buffer_load_dwordx4 v[88:91], v7, s[16:19], s42 offen offset:0
    buffer_load_dwordx4 v[92:95], v7, s[16:19], s42 offen offset:1024
    buffer_load_dwordx4 v[96:99], v7, s[16:19], s42 offen offset:2048
    s_add_u32 s42, s42, 3072
    buffer_load_dwordx4 v[100:103], v7, s[16:19], s42 offen offset:0
    buffer_load_dwordx4 v[104:107], v7, s[16:19], s42 offen offset:1024
    buffer_load_dwordx4 v[108:111], v7, s[16:19], s42 offen offset:2048
    s_add_u32 s42, s42, 3072
    buffer_load_dwordx4 v[112:115], v7, s[16:19], s42 offen offset:0
    buffer_load_dwordx4 v[116:119], v7, s[16:19], s42 offen offset:1024
    buffer_load_dwordx4 v[120:123], v7, s[16:19], s42 offen offset:2048
    s_add_u32 s42, s42, 3072
    v_mov_b32 v124, 0
    v_mov_b32 v125, 0
    v_mov_b32 v126, 0
    v_mov_b32 v127, 0
    v_mov_b32 v128, 0
    v_mov_b32 v129, 0
    v_mov_b32 v130, 0
    v_mov_b32 v131, 0
    v_mov_b32 v132, 0
    v_mov_b32 v133, 0
    v_mov_b32 v134, 0
    v_mov_b32 v135, 0
    s_mov_b32 s84, 0x4000
Lp3:
    buffer_load_dwordx2 v[12:13], v10, s[12:15], s31 offen sc1
    s_waitcnt vmcnt(0)
    v_min_u32 v9, v12, v13
    v_cmp_eq_u32 vcc, 0, v9
    s_sub_u32 s84, s84, 1
    s_cbranch_scc1 Lp3_x
    s_cbranch_vccnz Lp3
Lp3_x:
    buffer_load_dwordx4 v[148:151], v2, s[12:15], s27 offen sc1
    s_add_u32 s27, s27, 4096
    buffer_load_dwordx4 v[152:155], v2, s[12:15], s27 offen sc1
    s_add_u32 s27, s27, 4096
    buffer_load_dwordx4 v[156:159], v2, s[12:15], s27 offen sc1
    s_add_u32 s27, s27, 4096
    buffer_load_dwordx4 v[160:163], v2, s[12:15], s27 offen sc1
    s_add_u32 s27, s27, 4096
    buffer_load_dwordx4 v[164:167], v2, s[12:15], s27 offen sc1
    s_add_u32 s27, s27, 4096
    buffer_load_dwordx4 v[168:171], v2, s[12:15], s27 offen sc1
    s_add_u32 s27, s27, 4096
    v_permlane16_swap_b32 v12, v13
    v_add_f32 v12, v12, v13
    v_mov_b32 v14, v12
    s_nop 1
    v_permlane32_swap_b32 v12, v14
    v_add_f32 v12, v12, v14
    v_mov_b32 v14, v12
    s_nop 1
    v_permlane16_swap_b32 v12, v14
    v_mul_f32 v12, 0xbae38e39, v12
    v_mul_f32 v14, 0x3ae38e39, v14
    v_fma_f32 v14, -v12, v12, v14
    v_max_f32 v14, 0, v14
    v_add_f32 v14, 0x3727c5ac, v14
    v_rsq_f32 v14, v14
    s_nop 0
    v_mul_f32 v15, v12, v14
    s_waitcnt vmcnt(5)
    buffer_load_dwordx4 v[172:175], v2, s[12:15], s27 offen sc1
    s_add_u32 s27, s27, 4096
    v_lshlrev_b32 v220, 16, v148
    v_and_b32 v221, s38, v148
    v_lshlrev_b32 v222, 16, v149
    v_and_b32 v223, s38, v149
    v_lshlrev_b32 v224, 16, v150
    v_and_b32 v225, s38, v150
    v_lshlrev_b32 v226, 16, v151
    v_and_b32 v227, s38, v151
    v_fma_f32 v220, v220, v14, v15
    v_fma_f32 v221, v221, v14, v15
    v_fma_f32 v222, v222, v14, v15
    v_fma_f32 v223, v223, v14, v15
    v_fma_f32 v224, v224, v14, v15
    v_fma_f32 v225, v225, v14, v15
    v_fma_f32 v226, v226, v14, v15
    v_fma_f32 v227, v227, v14, v15
    v_cvt_pk_bf16_f32 v148, v220, v221
    v_cvt_pk_bf16_f32 v149, v222, v223
    v_cvt_pk_bf16_f32 v150, v224, v225
    v_cvt_pk_bf16_f32 v151, v226, v227
    ds_write_b128 v2, v[148:151] offset:0
    s_waitcnt vmcnt(5)
    buffer_load_dwordx4 v[176:179], v2, s[12:15], s27 offen sc1
    s_add_u32 s27, s27, 4096
    v_lshlrev_b32 v228, 16, v152
    v_and_b32 v229, s38, v152
    v_lshlrev_b32 v230, 16, v153
    v_and_b32 v231, s38, v153
    v_lshlrev_b32 v232, 16, v154
    v_and_b32 v233, s38, v154
    v_lshlrev_b32 v234, 16, v155
    v_and_b32 v235, s38, v155
    v_fma_f32 v228, v228, v14, v15
    v_fma_f32 v229, v229, v14, v15
    v_fma_f32 v230, v230, v14, v15
    v_fma_f32 v231, v231, v14, v15
    v_fma_f32 v232, v232, v14, v15
    v_fma_f32 v233, v233, v14, v15
    v_fma_f32 v234, v234, v14, v15
    v_fma_f32 v235, v235, v14, v15
    v_cvt_pk_bf16_f32 v152, v228, v229
    v_cvt_pk_bf16_f32 v153, v230, v231
    v_cvt_pk_bf16_f32 v154, v232, v233
    v_cvt_pk_bf16_f32 v155, v234, v235
    ds_write_b128 v2, v[152:155] offset:4096
    s_waitcnt vmcnt(5)
    buffer_load_dwordx4 v[180:183], v2, s[12:15], s27 offen sc1
    s_add_u32 s27, s27, 4096
    v_lshlrev_b32 v236, 16, v156
    v_and_b32 v237, s38, v156
    v_lshlrev_b32 v238, 16, v157
    v_and_b32 v239, s38, v157
    v_lshlrev_b32 v240, 16, v158
    v_and_b32 v241, s38, v158
    v_lshlrev_b32 v242, 16, v159
    v_and_b32 v243, s38, v159
    v_fma_f32 v236, v236, v14, v15
    v_fma_f32 v237, v237, v14, v15
    v_fma_f32 v238, v238, v14, v15
    v_fma_f32 v239, v239, v14, v15
    v_fma_f32 v240, v240, v14, v15
    v_fma_f32 v241, v241, v14, v15
    v_fma_f32 v242, v242, v14, v15
    v_fma_f32 v243, v243, v14, v15
    v_cvt_pk_bf16_f32 v156, v236, v237
    v_cvt_pk_bf16_f32 v157, v238, v239
    v_cvt_pk_bf16_f32 v158, v240, v241
    v_cvt_pk_bf16_f32 v159, v242, v243
    ds_write_b128 v2, v[156:159] offset:8192
    s_waitcnt lgkmcnt(0)
    s_barrier
    s_waitcnt vmcnt(5)
    buffer_load_dwordx4 v[184:187], v2, s[12:15], s27 offen sc1
    s_add_u32 s27, s27, 4096
    v_lshlrev_b32 v220, 16, v160
    v_and_b32 v221, s38, v160
    v_lshlrev_b32 v222, 16, v161
    v_and_b32 v223, s38, v161
    v_lshlrev_b32 v224, 16, v162
    v_and_b32 v225, s38, v162
    v_lshlrev_b32 v226, 16, v163
    v_and_b32 v227, s38, v163
    v_fma_f32 v220, v220, v14, v15
    v_fma_f32 v221, v221, v14, v15
    v_fma_f32 v222, v222, v14, v15
    v_fma_f32 v223, v223, v14, v15
    v_fma_f32 v224, v224, v14, v15
    v_fma_f32 v225, v225, v14, v15
    v_fma_f32 v226, v226, v14, v15
    v_fma_f32 v227, v227, v14, v15
    v_cvt_pk_bf16_f32 v160, v220, v221
    v_cvt_pk_bf16_f32 v161, v222, v223
    v_cvt_pk_bf16_f32 v162, v224, v225
    v_cvt_pk_bf16_f32 v163, v226, v227
    ds_write_b128 v2, v[160:163] offset:12288
    s_waitcnt vmcnt(5)
    buffer_load_dwordx4 v[188:191], v2, s[12:15], s27 offen sc1
    s_add_u32 s27, s27, 4096
    v_lshlrev_b32 v228, 16, v164
    v_and_b32 v229, s38, v164
    v_lshlrev_b32 v230, 16, v165
    v_and_b32 v231, s38, v165
    v_lshlrev_b32 v232, 16, v166
    v_and_b32 v233, s38, v166
    v_lshlrev_b32 v234, 16, v167
    v_and_b32 v235, s38, v167
    v_fma_f32 v228, v228, v14, v15
    v_fma_f32 v229, v229, v14, v15
    v_fma_f32 v230, v230, v14, v15
    v_fma_f32 v231, v231, v14, v15
    v_fma_f32 v232, v232, v14, v15
    v_fma_f32 v233, v233, v14, v15
    v_fma_f32 v234, v234, v14, v15
    v_fma_f32 v235, v235, v14, v15
    v_cvt_pk_bf16_f32 v164, v228, v229
    v_cvt_pk_bf16_f32 v165, v230, v231
    v_cvt_pk_bf16_f32 v166, v232, v233
    v_cvt_pk_bf16_f32 v167, v234, v235
    ds_write_b128 v2, v[164:167] offset:16384
    s_waitcnt lgkmcnt(0)
    s_barrier
    s_waitcnt vmcnt(5)
    buffer_load_dwordx4 v[192:195], v2, s[12:15], s27 offen sc1
    s_add_u32 s27, s27, 4096
    v_lshlrev_b32 v236, 16, v168
    v_and_b32 v237, s38, v168
    v_lshlrev_b32 v238, 16, v169
    v_and_b32 v239, s38, v169
    v_lshlrev_b32 v240, 16, v170
    v_and_b32 v241, s38, v170
    v_lshlrev_b32 v242, 16, v171
    v_and_b32 v243, s38, v171
    v_fma_f32 v236, v236, v14, v15
    v_fma_f32 v237, v237, v14, v15
    v_fma_f32 v238, v238, v14, v15
    v_fma_f32 v239, v239, v14, v15
    v_fma_f32 v240, v240, v14, v15
    v_fma_f32 v241, v241, v14, v15
    v_fma_f32 v242, v242, v14, v15
    v_fma_f32 v243, v243, v14, v15
    v_cvt_pk_bf16_f32 v168, v236, v237
    v_cvt_pk_bf16_f32 v169, v238, v239
    v_cvt_pk_bf16_f32 v170, v240, v241
    v_cvt_pk_bf16_f32 v171, v242, v243
    ds_write_b128 v2, v[168:171] offset:20480
    s_waitcnt vmcnt(5)
    buffer_load_dwordx4 v[196:199], v2, s[12:15], s27 offen sc1
    s_add_u32 s27, s27, 4096
    v_lshlrev_b32 v220, 16, v172
    v_and_b32 v221, s38, v172
    v_lshlrev_b32 v222, 16, v173
    v_and_b32 v223, s38, v173
    v_lshlrev_b32 v224, 16, v174
    v_and_b32 v225, s38, v174
    v_lshlrev_b32 v226, 16, v175
    v_and_b32 v227, s38, v175
    v_fma_f32 v220, v220, v14, v15
    v_fma_f32 v221, v221, v14, v15
    v_fma_f32 v222, v222, v14, v15
    v_fma_f32 v223, v223, v14, v15
    v_fma_f32 v224, v224, v14, v15
    v_fma_f32 v225, v225, v14, v15
    v_fma_f32 v226, v226, v14, v15
    v_fma_f32 v227, v227, v14, v15
    v_cvt_pk_bf16_f32 v172, v220, v221
    v_cvt_pk_bf16_f32 v173, v222, v223
    v_cvt_pk_bf16_f32 v174, v224, v225
    v_cvt_pk_bf16_f32 v175, v226, v227
    ds_write_b128 v2, v[172:175] offset:24576
    s_waitcnt lgkmcnt(0)
    s_barrier
    s_waitcnt vmcnt(5)
    buffer_load_dwordx4 v[200:203], v2, s[12:15], s27 offen sc1
    s_add_u32 s27, s27, 4096
    v_lshlrev_b32 v228, 16, v176
    v_and_b32 v229, s38, v176
    v_lshlrev_b32 v230, 16, v177
    v_and_b32 v231, s38, v177
    v_lshlrev_b32 v232, 16, v178
    v_and_b32 v233, s38, v178
    v_lshlrev_b32 v234, 16, v179
    v_and_b32 v235, s38, v179
    v_fma_f32 v228, v228, v14, v15
    v_fma_f32 v229, v229, v14, v15
    v_fma_f32 v230, v230, v14, v15
    v_fma_f32 v231, v231, v14, v15
    v_fma_f32 v232, v232, v14, v15
    v_fma_f32 v233, v233, v14, v15
    v_fma_f32 v234, v234, v14, v15
    v_fma_f32 v235, v235, v14, v15
    v_cvt_pk_bf16_f32 v176, v228, v229
    v_cvt_pk_bf16_f32 v177, v230, v231
    v_cvt_pk_bf16_f32 v178, v232, v233
    v_cvt_pk_bf16_f32 v179, v234, v235
    ds_write_b128 v2, v[176:179] offset:28672
    s_waitcnt vmcnt(5)
    buffer_load_dwordx4 v[204:207], v2, s[12:15], s27 offen sc1
    s_add_u32 s27, s27, 4096
    v_lshlrev_b32 v236, 16, v180
    v_and_b32 v237, s38, v180
    v_lshlrev_b32 v238, 16, v181
    v_and_b32 v239, s38, v181
    v_lshlrev_b32 v240, 16, v182
    v_and_b32 v241, s38, v182
    v_lshlrev_b32 v242, 16, v183
    v_and_b32 v243, s38, v183
    v_fma_f32 v236, v236, v14, v15
    v_fma_f32 v237, v237, v14, v15
    v_fma_f32 v238, v238, v14, v15
    v_fma_f32 v239, v239, v14, v15
    v_fma_f32 v240, v240, v14, v15
    v_fma_f32 v241, v241, v14, v15
    v_fma_f32 v242, v242, v14, v15
    v_fma_f32 v243, v243, v14, v15
    v_cvt_pk_bf16_f32 v180, v236, v237
    v_cvt_pk_bf16_f32 v181, v238, v239
    v_cvt_pk_bf16_f32 v182, v240, v241
    v_cvt_pk_bf16_f32 v183, v242, v243
    ds_write_b128 v2, v[180:183] offset:32768
    s_waitcnt lgkmcnt(0)
    s_barrier
    s_waitcnt vmcnt(5)
    buffer_load_dwordx4 v[208:211], v2, s[12:15], s27 offen sc1
    s_add_u32 s27, s27, 4096
    v_lshlrev_b32 v220, 16, v184
    v_and_b32 v221, s38, v184
    v_lshlrev_b32 v222, 16, v185
    v_and_b32 v223, s38, v185
    v_lshlrev_b32 v224, 16, v186
    v_and_b32 v225, s38, v186
    v_lshlrev_b32 v226, 16, v187
    v_and_b32 v227, s38, v187
    v_fma_f32 v220, v220, v14, v15
    v_fma_f32 v221, v221, v14, v15
    v_fma_f32 v222, v222, v14, v15
    v_fma_f32 v223, v223, v14, v15
    v_fma_f32 v224, v224, v14, v15
    v_fma_f32 v225, v225, v14, v15
    v_fma_f32 v226, v226, v14, v15
    v_fma_f32 v227, v227, v14, v15
    v_cvt_pk_bf16_f32 v184, v220, v221
    v_cvt_pk_bf16_f32 v185, v222, v223
    v_cvt_pk_bf16_f32 v186, v224, v225
    v_cvt_pk_bf16_f32 v187, v226, v227
    ds_write_b128 v6, v[184:187] offset:0
    s_waitcnt vmcnt(5)
    buffer_load_dwordx4 v[212:215], v2, s[12:15], s27 offen sc1
    s_add_u32 s27, s27, 4096
    v_lshlrev_b32 v228, 16, v188
    v_and_b32 v229, s38, v188
    v_lshlrev_b32 v230, 16, v189
    v_and_b32 v231, s38, v189
    v_lshlrev_b32 v232, 16, v190
    v_and_b32 v233, s38, v190
    v_lshlrev_b32 v234, 16, v191
    v_and_b32 v235, s38, v191
    v_fma_f32 v228, v228, v14, v15
    v_fma_f32 v229, v229, v14, v15
    v_fma_f32 v230, v230, v14, v15
    v_fma_f32 v231, v231, v14, v15
    v_fma_f32 v232, v232, v14, v15
    v_fma_f32 v233, v233, v14, v15
    v_fma_f32 v234, v234, v14, v15
    v_fma_f32 v235, v235, v14, v15
    v_cvt_pk_bf16_f32 v188, v228, v229
    v_cvt_pk_bf16_f32 v189, v230, v231
    v_cvt_pk_bf16_f32 v190, v232, v233
    v_cvt_pk_bf16_f32 v191, v234, v235
    ds_write_b128 v6, v[188:191] offset:4096
    s_waitcnt vmcnt(5)
    buffer_load_dwordx4 v[216:219], v2, s[12:15], s27 offen sc1
    v_lshlrev_b32 v236, 16, v192
    v_and_b32 v237, s38, v192
    v_lshlrev_b32 v238, 16, v193
    v_and_b32 v239, s38, v193
    v_lshlrev_b32 v240, 16, v194
    v_and_b32 v241, s38, v194
    v_lshlrev_b32 v242, 16, v195
    v_and_b32 v243, s38, v195
    v_fma_f32 v236, v236, v14, v15
    v_fma_f32 v237, v237, v14, v15
    v_fma_f32 v238, v238, v14, v15
    v_fma_f32 v239, v239, v14, v15
    v_fma_f32 v240, v240, v14, v15
    v_fma_f32 v241, v241, v14, v15
    v_fma_f32 v242, v242, v14, v15
    v_fma_f32 v243, v243, v14, v15
    v_cvt_pk_bf16_f32 v192, v236, v237
    v_cvt_pk_bf16_f32 v193, v238, v239
    v_cvt_pk_bf16_f32 v194, v240, v241
    v_cvt_pk_bf16_f32 v195, v242, v243
    ds_write_b128 v6, v[192:195] offset:8192
    s_waitcnt lgkmcnt(0)
    s_barrier
    s_waitcnt vmcnt(5)
    v_lshlrev_b32 v11, 5, v11
    buffer_load_short_d16_hi v124, v11, s[20:23], s34 offen offset:0
    buffer_load_short_d16_hi v125, v11, s[20:23], s34 offen offset:8
    buffer_load_short_d16_hi v126, v11, s[20:23], s34 offen offset:16
    buffer_load_short_d16_hi v127, v11, s[20:23], s34 offen offset:24
    buffer_load_short_d16_hi v128, v11, s[20:23], s34 offen offset:128
    buffer_load_short_d16_hi v129, v11, s[20:23], s34 offen offset:136
    buffer_load_short_d16_hi v130, v11, s[20:23], s34 offen offset:144
    buffer_load_short_d16_hi v131, v11, s[20:23], s34 offen offset:152
    buffer_load_short_d16_hi v132, v11, s[20:23], s34 offen offset:256
    buffer_load_short_d16_hi v133, v11, s[20:23], s34 offen offset:264
    buffer_load_short_d16_hi v134, v11, s[20:23], s34 offen offset:272
    buffer_load_short_d16_hi v135, v11, s[20:23], s34 offen offset:280
    v_lshlrev_b32 v220, 16, v196
    v_and_b32 v221, s38, v196
    v_lshlrev_b32 v222, 16, v197
    v_and_b32 v223, s38, v197
    v_lshlrev_b32 v224, 16, v198
    v_and_b32 v225, s38, v198
    v_lshlrev_b32 v226, 16, v199
    v_and_b32 v227, s38, v199
    v_fma_f32 v220, v220, v14, v15
    v_fma_f32 v221, v221, v14, v15
    v_fma_f32 v222, v222, v14, v15
    v_fma_f32 v223, v223, v14, v15
    v_fma_f32 v224, v224, v14, v15
    v_fma_f32 v225, v225, v14, v15
    v_fma_f32 v226, v226, v14, v15
    v_fma_f32 v227, v227, v14, v15
    v_cvt_pk_bf16_f32 v196, v220, v221
    v_cvt_pk_bf16_f32 v197, v222, v223
    v_cvt_pk_bf16_f32 v198, v224, v225
    v_cvt_pk_bf16_f32 v199, v226, v227
    ds_write_b128 v6, v[196:199] offset:12288
    s_waitcnt vmcnt(16)
    v_lshlrev_b32 v228, 16, v200
    v_and_b32 v229, s38, v200
    v_lshlrev_b32 v230, 16, v201
    v_and_b32 v231, s38, v201
    v_lshlrev_b32 v232, 16, v202
    v_and_b32 v233, s38, v202
    v_lshlrev_b32 v234, 16, v203
    v_and_b32 v235, s38, v203
    v_fma_f32 v228, v228, v14, v15
    v_fma_f32 v229, v229, v14, v15
    v_fma_f32 v230, v230, v14, v15
    v_fma_f32 v231, v231, v14, v15
    v_fma_f32 v232, v232, v14, v15
    v_fma_f32 v233, v233, v14, v15
    v_fma_f32 v234, v234, v14, v15
    v_fma_f32 v235, v235, v14, v15
    v_cvt_pk_bf16_f32 v200, v228, v229
    v_cvt_pk_bf16_f32 v201, v230, v231
    v_cvt_pk_bf16_f32 v202, v232, v233
    v_cvt_pk_bf16_f32 v203, v234, v235
    ds_write_b128 v6, v[200:203] offset:16384
    s_waitcnt lgkmcnt(0)
    s_barrier
    s_waitcnt vmcnt(15)
    v_lshlrev_b32 v236, 16, v204
    v_and_b32 v237, s38, v204
    v_lshlrev_b32 v238, 16, v205
    v_and_b32 v239, s38, v205
    v_lshlrev_b32 v240, 16, v206
    v_and_b32 v241, s38, v206
    v_lshlrev_b32 v242, 16, v207
    v_and_b32 v243, s38, v207
    v_fma_f32 v236, v236, v14, v15
    v_fma_f32 v237, v237, v14, v15
    v_fma_f32 v238, v238, v14, v15
    v_fma_f32 v239, v239, v14, v15
    v_fma_f32 v240, v240, v14, v15
    v_fma_f32 v241, v241, v14, v15
    v_fma_f32 v242, v242, v14, v15
    v_fma_f32 v243, v243, v14, v15
    v_cvt_pk_bf16_f32 v204, v236, v237
    v_cvt_pk_bf16_f32 v205, v238, v239
    v_cvt_pk_bf16_f32 v206, v240, v241
    v_cvt_pk_bf16_f32 v207, v242, v243
    ds_write_b128 v6, v[204:207] offset:20480
    s_waitcnt vmcnt(14)
    v_lshlrev_b32 v220, 16, v208
    v_and_b32 v221, s38, v208
    v_lshlrev_b32 v222, 16, v209
    v_and_b32 v223, s38, v209
    v_lshlrev_b32 v224, 16, v210
    v_and_b32 v225, s38, v210
    v_lshlrev_b32 v226, 16, v211
    v_and_b32 v227, s38, v211
    v_fma_f32 v220, v220, v14, v15
    v_fma_f32 v221, v221, v14, v15
    v_fma_f32 v222, v222, v14, v15
    v_fma_f32 v223, v223, v14, v15
    v_fma_f32 v224, v224, v14, v15
    v_fma_f32 v225, v225, v14, v15
    v_fma_f32 v226, v226, v14, v15
    v_fma_f32 v227, v227, v14, v15
    v_cvt_pk_bf16_f32 v208, v220, v221
    v_cvt_pk_bf16_f32 v209, v222, v223
    v_cvt_pk_bf16_f32 v210, v224, v225
    v_cvt_pk_bf16_f32 v211, v226, v227
    ds_write_b128 v6, v[208:211] offset:24576
    s_waitcnt lgkmcnt(0)
    s_barrier
    s_waitcnt vmcnt(13)
    v_lshlrev_b32 v228, 16, v212
    v_and_b32 v229, s38, v212
    v_lshlrev_b32 v230, 16, v213
    v_and_b32 v231, s38, v213
    v_lshlrev_b32 v232, 16, v214
    v_and_b32 v233, s38, v214
    v_lshlrev_b32 v234, 16, v215
    v_and_b32 v235, s38, v215
    v_fma_f32 v228, v228, v14, v15
    v_fma_f32 v229, v229, v14, v15
    v_fma_f32 v230, v230, v14, v15
    v_fma_f32 v231, v231, v14, v15
    v_fma_f32 v232, v232, v14, v15
    v_fma_f32 v233, v233, v14, v15
    v_fma_f32 v234, v234, v14, v15
    v_fma_f32 v235, v235, v14, v15
    v_cvt_pk_bf16_f32 v212, v228, v229
    v_cvt_pk_bf16_f32 v213, v230, v231
    v_cvt_pk_bf16_f32 v214, v232, v233
    v_cvt_pk_bf16_f32 v215, v234, v235
    ds_write_b128 v6, v[212:215] offset:28672
    s_waitcnt vmcnt(12)
    v_lshlrev_b32 v236, 16, v216
    v_and_b32 v237, s38, v216
    v_lshlrev_b32 v238, 16, v217
    v_and_b32 v239, s38, v217
    v_lshlrev_b32 v240, 16, v218
    v_and_b32 v241, s38, v218
    v_lshlrev_b32 v242, 16, v219
    v_and_b32 v243, s38, v219
    v_fma_f32 v236, v236, v14, v15
    v_fma_f32 v237, v237, v14, v15
    v_fma_f32 v238, v238, v14, v15
    v_fma_f32 v239, v239, v14, v15
    v_fma_f32 v240, v240, v14, v15
    v_fma_f32 v241, v241, v14, v15
    v_fma_f32 v242, v242, v14, v15
    v_fma_f32 v243, v243, v14, v15
    v_cvt_pk_bf16_f32 v216, v236, v237
    v_cvt_pk_bf16_f32 v217, v238, v239
    v_cvt_pk_bf16_f32 v218, v240, v241
    v_cvt_pk_bf16_f32 v219, v242, v243
    ds_write_b128 v6, v[216:219] offset:32768
    s_waitcnt lgkmcnt(0)
    s_barrier
    s_setprio 0
Lf0:
    s_mov_b32 s40, 0
    s_mov_b32 s44, 0xc0135761
    v_mov_b32 v9, 0xbdd2d3e8
    v_mov_b32 v8, v9
    s_mov_b32 s48, s44
    s_mov_b32 s49, s44
    s_mul_i32 s45, s2, 73728
    s_mul_i32 s28, s43, 18432
    s_add_u32 s45, s45, s28
    s_add_u32 s45, s45, 33554432
    s_lshl2_add_u32 s46, s59, s43
    s_lshl_b32 s46, s46, 7
    s_lshl2_add_u32 s46, s3, s46
    s_add_u32 s46, s46, 54525952
    v_mov_b32 v3, v7
    s_waitcnt vmcnt(0) lgkmcnt(0)
    s_cmp_eq_u32 s41, 0
    s_cbranch_scc0 Lphase
    s_barrier
    s_setprio 2
    s_branch Lphase2
Lphase:
    s_setprio 1
Lphase2:
    ds_read_b128 v[196:199], v3 offset:0
    ds_read_b128 v[200:203], v3 offset:1024
    ds_read_b128 v[204:207], v3 offset:2048
    ds_read_b128 v[208:211], v3 offset:3072
    s_lshl3_add_u32 s47, s41, s40
    s_waitcnt vmcnt(24) lgkmcnt(0)
    v_mfma_f32_16x16x32_bf16 v[148:151], v[16:19], v[196:199], v[124:127]
    ds_read_b128 v[212:215], v3 offset:4096
    v_mfma_f32_16x16x32_bf16 v[152:155], v[16:19], v[200:203], v[124:127]
    v_mfma_f32_16x16x32_bf16 v[156:159], v[16:19], v[204:207], v[124:127]
    ds_read_b128 v[216:219], v3 offset:5120
    v_mfma_f32_16x16x32_bf16 v[160:163], v[16:19], v[208:211], v[124:127]
    v_mfma_f32_16x16x32_bf16 v[164:167], v[20:23], v[196:199], v[128:131]
    ds_read_b128 v[220:223], v3 offset:6144
    v_mfma_f32_16x16x32_bf16 v[168:171], v[20:23], v[200:203], v[128:131]
    buffer_load_dwordx4 v[16:19], v7, s[16:19], s42 offen offset:0
    v_mfma_f32_16x16x32_bf16 v[172:175], v[20:23], v[204:207], v[128:131]
    ds_read_b128 v[224:227], v3 offset:7168
    v_mfma_f32_16x16x32_bf16 v[176:179], v[20:23], v[208:211], v[128:131]
    v_mfma_f32_16x16x32_bf16 v[180:183], v[24:27], v[196:199], v[132:135]
    buffer_load_dwordx4 v[20:23], v7, s[16:19], s42 offen offset:1024
    v_mfma_f32_16x16x32_bf16 v[184:187], v[24:27], v[200:203], v[132:135]
    v_mfma_f32_16x16x32_bf16 v[188:191], v[24:27], v[204:207], v[132:135]
    v_mfma_f32_16x16x32_bf16 v[192:195], v[24:27], v[208:211], v[132:135]
    buffer_load_dwordx4 v[24:27], v7, s[16:19], s42 offen offset:2048
    s_add_u32 s42, s42, 3072
    s_branch Lstep1
Lhalf:
    s_lshl3_add_u32 s47, s41, s40
    s_waitcnt vmcnt(24) lgkmcnt(0)
    v_mfma_f32_16x16x32_bf16 v[148:151], v[16:19], v[196:199], v[148:151]
    ds_read_b128 v[212:215], v3 offset:4096
    v_mfma_f32_16x16x32_bf16 v[152:155], v[16:19], v[200:203], v[152:155]
    v_mfma_f32_16x16x32_bf16 v[156:159], v[16:19], v[204:207], v[156:159]
    ds_read_b128 v[216:219], v3 offset:5120
    v_mfma_f32_16x16x32_bf16 v[160:163], v[16:19], v[208:211], v[160:163]
    v_mfma_f32_16x16x32_bf16 v[164:167], v[20:23], v[196:199], v[164:167]
    ds_read_b128 v[220:223], v3 offset:6144
    v_mfma_f32_16x16x32_bf16 v[168:171], v[20:23], v[200:203], v[168:171]
    buffer_load_dwordx4 v[16:19], v7, s[16:19], s42 offen offset:0
    v_mfma_f32_16x16x32_bf16 v[172:175], v[20:23], v[204:207], v[172:175]
    ds_read_b128 v[224:227], v3 offset:7168
    v_mfma_f32_16x16x32_bf16 v[176:179], v[20:23], v[208:211], v[176:179]
    v_mfma_f32_16x16x32_bf16 v[180:183], v[24:27], v[196:199], v[180:183]
    buffer_load_dwordx4 v[20:23], v7, s[16:19], s42 offen offset:1024
    v_mfma_f32_16x16x32_bf16 v[184:187], v[24:27], v[200:203], v[184:187]
    v_mfma_f32_16x16x32_bf16 v[188:191], v[24:27], v[204:207], v[188:191]
    v_mfma_f32_16x16x32_bf16 v[192:195], v[24:27], v[208:211], v[192:195]
    buffer_load_dwordx4 v[24:27], v7, s[16:19], s42 offen offset:2048
    s_add_u32 s42, s42, 3072
Lstep1:
    s_waitcnt vmcnt(24) lgkmcnt(0)
    v_mfma_f32_16x16x32_bf16 v[148:151], v[28:31], v[212:215], v[148:151]
    ds_read_b128 v[228:231], v3 offset:8192
    v_mfma_f32_16x16x32_bf16 v[152:155], v[28:31], v[216:219], v[152:155]
    v_mfma_f32_16x16x32_bf16 v[156:159], v[28:31], v[220:223], v[156:159]
    ds_read_b128 v[232:235], v3 offset:9216
    v_mfma_f32_16x16x32_bf16 v[160:163], v[28:31], v[224:227], v[160:163]
    v_mfma_f32_16x16x32_bf16 v[164:167], v[32:35], v[212:215], v[164:167]
    ds_read_b128 v[236:239], v3 offset:10240
    v_mfma_f32_16x16x32_bf16 v[168:171], v[32:35], v[216:219], v[168:171]
    buffer_load_dwordx4 v[28:31], v7, s[16:19], s42 offen offset:0
    v_mfma_f32_16x16x32_bf16 v[172:175], v[32:35], v[220:223], v[172:175]
    ds_read_b128 v[240:243], v3 offset:11264
    v_mfma_f32_16x16x32_bf16 v[176:179], v[32:35], v[224:227], v[176:179]
    v_mfma_f32_16x16x32_bf16 v[180:183], v[36:39], v[212:215], v[180:183]
    buffer_load_dwordx4 v[32:35], v7, s[16:19], s42 offen offset:1024
    v_mfma_f32_16x16x32_bf16 v[184:187], v[36:39], v[216:219], v[184:187]
    v_mfma_f32_16x16x32_bf16 v[188:191], v[36:39], v[220:223], v[188:191]
    v_mfma_f32_16x16x32_bf16 v[192:195], v[36:39], v[224:227], v[192:195]
    buffer_load_dwordx4 v[36:39], v7, s[16:19], s42 offen offset:2048
    s_add_u32 s42, s42, 3072
    s_bitcmp1_b32 2051, s47
    s_cbranch_scc0 Lnobar2
    s_waitcnt vmcnt(24)
    s_barrier
Lnobar2:
    s_waitcnt vmcnt(24) lgkmcnt(0)
    v_mfma_f32_16x16x32_bf16 v[148:151], v[40:43], v[228:231], v[148:151]
    ds_read_b128 v[196:199], v3 offset:12288
    v_mfma_f32_16x16x32_bf16 v[152:155], v[40:43], v[232:235], v[152:155]
    v_mfma_f32_16x16x32_bf16 v[156:159], v[40:43], v[236:239], v[156:159]
    ds_read_b128 v[200:203], v3 offset:13312
    v_mfma_f32_16x16x32_bf16 v[160:163], v[40:43], v[240:243], v[160:163]
    v_mfma_f32_16x16x32_bf16 v[164:167], v[44:47], v[228:231], v[164:167]
    ds_read_b128 v[204:207], v3 offset:14336
    v_mfma_f32_16x16x32_bf16 v[168:171], v[44:47], v[232:235], v[168:171]
    buffer_load_dwordx4 v[40:43], v7, s[16:19], s42 offen offset:0
    v_mfma_f32_16x16x32_bf16 v[172:175], v[44:47], v[236:239], v[172:175]
    ds_read_b128 v[208:211], v3 offset:15360
    v_mfma_f32_16x16x32_bf16 v[176:179], v[44:47], v[240:243], v[176:179]
    v_mfma_f32_16x16x32_bf16 v[180:183], v[48:51], v[228:231], v[180:183]
    buffer_load_dwordx4 v[44:47], v7, s[16:19], s42 offen offset:1024
    v_mfma_f32_16x16x32_bf16 v[184:187], v[48:51], v[232:235], v[184:187]
    v_mfma_f32_16x16x32_bf16 v[188:191], v[48:51], v[236:239], v[188:191]
    v_mfma_f32_16x16x32_bf16 v[192:195], v[48:51], v[240:243], v[192:195]
    buffer_load_dwordx4 v[48:51], v7, s[16:19], s42 offen offset:2048
    s_add_u32 s42, s42, 3072
    s_waitcnt vmcnt(24) lgkmcnt(0)
    v_mfma_f32_16x16x32_bf16 v[148:151], v[52:55], v[196:199], v[148:151]
    ds_read_b128 v[212:215], v3 offset:16384
    v_mfma_f32_16x16x32_bf16 v[152:155], v[52:55], v[200:203], v[152:155]
    v_mfma_f32_16x16x32_bf16 v[156:159], v[52:55], v[204:207], v[156:159]
    ds_read_b128 v[216:219], v3 offset:17408
    v_mfma_f32_16x16x32_bf16 v[160:163], v[52:55], v[208:211], v[160:163]
    v_mfma_f32_16x16x32_bf16 v[164:167], v[56:59], v[196:199], v[164:167]
    ds_read_b128 v[220:223], v3 offset:18432
    v_mfma_f32_16x16x32_bf16 v[168:171], v[56:59], v[200:203], v[168:171]
    buffer_load_dwordx4 v[52:55], v7, s[16:19], s42 offen offset:0
    v_mfma_f32_16x16x32_bf16 v[172:175], v[56:59], v[204:207], v[172:175]
    ds_read_b128 v[224:227], v3 offset:19456
    v_mfma_f32_16x16x32_bf16 v[176:179], v[56:59], v[208:211], v[176:179]
    v_mfma_f32_16x16x32_bf16 v[180:183], v[60:63], v[196:199], v[180:183]
    buffer_load_dwordx4 v[56:59], v7, s[16:19], s42 offen offset:1024
    v_mfma_f32_16x16x32_bf16 v[184:187], v[60:63], v[200:203], v[184:187]
    v_mfma_f32_16x16x32_bf16 v[188:191], v[60:63], v[204:207], v[188:191]
    v_mfma_f32_16x16x32_bf16 v[192:195], v[60:63], v[208:211], v[192:195]
    buffer_load_dwordx4 v[60:63], v7, s[16:19], s42 offen offset:2048
    s_add_u32 s42, s42, 3072
    s_bitcmp1_b32 3, s47
    s_cbranch_scc0 Lnobar4
    s_waitcnt vmcnt(24)
    s_barrier
Lnobar4:
    s_waitcnt vmcnt(24) lgkmcnt(0)
    v_mfma_f32_16x16x32_bf16 v[148:151], v[64:67], v[212:215], v[148:151]
    ds_read_b128 v[228:231], v3 offset:20480
    v_mfma_f32_16x16x32_bf16 v[152:155], v[64:67], v[216:219], v[152:155]
    v_mfma_f32_16x16x32_bf16 v[156:159], v[64:67], v[220:223], v[156:159]
    ds_read_b128 v[232:235], v3 offset:21504
    v_mfma_f32_16x16x32_bf16 v[160:163], v[64:67], v[224:227], v[160:163]
    v_mfma_f32_16x16x32_bf16 v[164:167], v[68:71], v[212:215], v[164:167]
    ds_read_b128 v[236:239], v3 offset:22528
    v_mfma_f32_16x16x32_bf16 v[168:171], v[68:71], v[216:219], v[168:171]
    buffer_load_dwordx4 v[64:67], v7, s[16:19], s42 offen offset:0
    v_mfma_f32_16x16x32_bf16 v[172:175], v[68:71], v[220:223], v[172:175]
    ds_read_b128 v[240:243], v3 offset:23552
    v_mfma_f32_16x16x32_bf16 v[176:179], v[68:71], v[224:227], v[176:179]
    v_mfma_f32_16x16x32_bf16 v[180:183], v[72:75], v[212:215], v[180:183]
    buffer_load_dwordx4 v[68:71], v7, s[16:19], s42 offen offset:1024
    v_mfma_f32_16x16x32_bf16 v[184:187], v[72:75], v[216:219], v[184:187]
    v_mfma_f32_16x16x32_bf16 v[188:191], v[72:75], v[220:223], v[188:191]
    v_mfma_f32_16x16x32_bf16 v[192:195], v[72:75], v[224:227], v[192:195]
    buffer_load_dwordx4 v[72:75], v7, s[16:19], s42 offen offset:2048
    s_add_u32 s42, s42, 3072
    s_waitcnt vmcnt(24) lgkmcnt(0)
    v_mfma_f32_16x16x32_bf16 v[148:151], v[76:79], v[228:231], v[148:151]
    ds_read_b128 v[196:199], v3 offset:24576
    v_mfma_f32_16x16x32_bf16 v[152:155], v[76:79], v[232:235], v[152:155]
    v_mfma_f32_16x16x32_bf16 v[156:159], v[76:79], v[236:239], v[156:159]
    ds_read_b128 v[200:203], v3 offset:25600
    v_mfma_f32_16x16x32_bf16 v[160:163], v[76:79], v[240:243], v[160:163]
    v_mfma_f32_16x16x32_bf16 v[164:167], v[80:83], v[228:231], v[164:167]
    ds_read_b128 v[204:207], v3 offset:26624
    v_mfma_f32_16x16x32_bf16 v[168:171], v[80:83], v[232:235], v[168:171]
    buffer_load_dwordx4 v[76:79], v7, s[16:19], s42 offen offset:0
    v_mfma_f32_16x16x32_bf16 v[172:175], v[80:83], v[236:239], v[172:175]
    ds_read_b128 v[208:211], v3 offset:27648
    v_mfma_f32_16x16x32_bf16 v[176:179], v[80:83], v[240:243], v[176:179]
    v_mfma_f32_16x16x32_bf16 v[180:183], v[84:87], v[228:231], v[180:183]
    buffer_load_dwordx4 v[80:83], v7, s[16:19], s42 offen offset:1024
    v_mfma_f32_16x16x32_bf16 v[184:187], v[84:87], v[232:235], v[184:187]
    v_mfma_f32_16x16x32_bf16 v[188:191], v[84:87], v[236:239], v[188:191]
    v_mfma_f32_16x16x32_bf16 v[192:195], v[84:87], v[240:243], v[192:195]
    buffer_load_dwordx4 v[84:87], v7, s[16:19], s42 offen offset:2048
    s_add_u32 s42, s42, 3072
    s_bitcmp1_b32 2051, s47
    s_cbranch_scc0 Lnobar6
    s_waitcnt vmcnt(24)
    s_barrier
Lnobar6:
    s_waitcnt vmcnt(24) lgkmcnt(0)
    v_mfma_f32_16x16x32_bf16 v[148:151], v[88:91], v[196:199], v[148:151]
    ds_read_b128 v[212:215], v3 offset:28672
    v_mfma_f32_16x16x32_bf16 v[152:155], v[88:91], v[200:203], v[152:155]
    v_mfma_f32_16x16x32_bf16 v[156:159], v[88:91], v[204:207], v[156:159]
    ds_read_b128 v[216:219], v3 offset:29696
    v_mfma_f32_16x16x32_bf16 v[160:163], v[88:91], v[208:211], v[160:163]
    v_mfma_f32_16x16x32_bf16 v[164:167], v[92:95], v[196:199], v[164:167]
    ds_read_b128 v[220:223], v3 offset:30720
    v_mfma_f32_16x16x32_bf16 v[168:171], v[92:95], v[200:203], v[168:171]
    buffer_load_dwordx4 v[88:91], v7, s[16:19], s42 offen offset:0
    v_mfma_f32_16x16x32_bf16 v[172:175], v[92:95], v[204:207], v[172:175]
    ds_read_b128 v[224:227], v3 offset:31744
    v_mfma_f32_16x16x32_bf16 v[176:179], v[92:95], v[208:211], v[176:179]
    v_mfma_f32_16x16x32_bf16 v[180:183], v[96:99], v[196:199], v[180:183]
    buffer_load_dwordx4 v[92:95], v7, s[16:19], s42 offen offset:1024
    v_mfma_f32_16x16x32_bf16 v[184:187], v[96:99], v[200:203], v[184:187]
    v_mfma_f32_16x16x32_bf16 v[188:191], v[96:99], v[204:207], v[188:191]
    v_mfma_f32_16x16x32_bf16 v[192:195], v[96:99], v[208:211], v[192:195]
    buffer_load_dwordx4 v[96:99], v7, s[16:19], s42 offen offset:2048
    s_add_u32 s42, s42, 3072
    s_waitcnt vmcnt(24) lgkmcnt(0)
    v_mfma_f32_16x16x32_bf16 v[148:151], v[100:103], v[212:215], v[148:151]
    ds_read_b128 v[228:231], v3 offset:32768
    v_mfma_f32_16x16x32_bf16 v[152:155], v[100:103], v[216:219], v[152:155]
    v_mfma_f32_16x16x32_bf16 v[156:159], v[100:103], v[220:223], v[156:159]
    ds_read_b128 v[232:235], v3 offset:33792
    v_mfma_f32_16x16x32_bf16 v[160:163], v[100:103], v[224:227], v[160:163]
    v_mfma_f32_16x16x32_bf16 v[164:167], v[104:107], v[212:215], v[164:167]
    ds_read_b128 v[236:239], v3 offset:34816
    v_mfma_f32_16x16x32_bf16 v[168:171], v[104:107], v[216:219], v[168:171]
    buffer_load_dwordx4 v[100:103], v7, s[16:19], s42 offen offset:0
    v_mfma_f32_16x16x32_bf16 v[172:175], v[104:107], v[220:223], v[172:175]
    ds_read_b128 v[240:243], v3 offset:35840
    v_mfma_f32_16x16x32_bf16 v[176:179], v[104:107], v[224:227], v[176:179]
    v_mfma_f32_16x16x32_bf16 v[180:183], v[108:111], v[212:215], v[180:183]
    buffer_load_dwordx4 v[104:107], v7, s[16:19], s42 offen offset:1024
    v_mfma_f32_16x16x32_bf16 v[184:187], v[108:111], v[216:219], v[184:187]
    v_mfma_f32_16x16x32_bf16 v[188:191], v[108:111], v[220:223], v[188:191]
    v_mfma_f32_16x16x32_bf16 v[192:195], v[108:111], v[224:227], v[192:195]
    buffer_load_dwordx4 v[108:111], v7, s[16:19], s42 offen offset:2048
    s_add_u32 s42, s42, 3072
    s_bitcmp1_b32 4113, s47
    s_cbranch_scc0 Lnobar8
    s_waitcnt vmcnt(24)
    s_barrier
Lnobar8:
    s_waitcnt vmcnt(24) lgkmcnt(0)
    v_mfma_f32_16x16x32_bf16 v[148:151], v[112:115], v[228:231], v[148:151]
    ds_read_b128 v[196:199], v3 offset:36864
    v_mfma_f32_16x16x32_bf16 v[152:155], v[112:115], v[232:235], v[152:155]
    v_mfma_f32_16x16x32_bf16 v[156:159], v[112:115], v[236:239], v[156:159]
    ds_read_b128 v[200:203], v3 offset:37888
    v_mfma_f32_16x16x32_bf16 v[160:163], v[112:115], v[240:243], v[160:163]
    v_mfma_f32_16x16x32_bf16 v[164:167], v[116:119], v[228:231], v[164:167]
    ds_read_b128 v[204:207], v3 offset:38912
    v_mfma_f32_16x16x32_bf16 v[168:171], v[116:119], v[232:235], v[168:171]
    buffer_load_dwordx4 v[112:115], v7, s[16:19], s42 offen offset:0
    v_mfma_f32_16x16x32_bf16 v[172:175], v[116:119], v[236:239], v[172:175]
    ds_read_b128 v[208:211], v3 offset:39936
    v_mfma_f32_16x16x32_bf16 v[176:179], v[116:119], v[240:243], v[176:179]
    v_mfma_f32_16x16x32_bf16 v[180:183], v[120:123], v[228:231], v[180:183]
    buffer_load_dwordx4 v[116:119], v7, s[16:19], s42 offen offset:1024
    v_mfma_f32_16x16x32_bf16 v[184:187], v[120:123], v[232:235], v[184:187]
    v_mfma_f32_16x16x32_bf16 v[188:191], v[120:123], v[236:239], v[188:191]
    v_mfma_f32_16x16x32_bf16 v[192:195], v[120:123], v[240:243], v[192:195]
    buffer_load_dwordx4 v[120:123], v7, s[16:19], s42 offen offset:2048
    s_add_u32 s42, s42, 3072
    s_add_u32 s40, s40, 1
    s_bitcmp1_b32 s40, 0
    s_cbranch_scc0 Lepi
    s_setprio 2
    v_add_u32 v3, 36864, v3
    s_add_u32 s42, s42, 387072
    s_cmp_eq_u32 s40, 5
    s_cbranch_scc0 Lhalf
    s_waitcnt vmcnt(24) lgkmcnt(0)
    v_mfma_f32_16x16x32_bf16 v[148:151], v[16:19], v[196:199], v[148:151]
    ds_read_b128 v[212:215], v3 offset:4096
    v_mfma_f32_16x16x32_bf16 v[152:155], v[16:19], v[200:203], v[152:155]
    v_mfma_f32_16x16x32_bf16 v[156:159], v[16:19], v[204:207], v[156:159]
    ds_read_b128 v[216:219], v3 offset:5120
    v_mfma_f32_16x16x32_bf16 v[160:163], v[16:19], v[208:211], v[160:163]
    v_mfma_f32_16x16x32_bf16 v[164:167], v[20:23], v[196:199], v[164:167]
    ds_read_b128 v[220:223], v3 offset:6144
    v_mfma_f32_16x16x32_bf16 v[168:171], v[20:23], v[200:203], v[168:171]
    v_mfma_f32_16x16x32_bf16 v[172:175], v[20:23], v[204:207], v[172:175]
    ds_read_b128 v[224:227], v3 offset:7168
    v_mfma_f32_16x16x32_bf16 v[176:179], v[20:23], v[208:211], v[176:179]
    v_mfma_f32_16x16x32_bf16 v[180:183], v[24:27], v[196:199], v[180:183]
    v_mfma_f32_16x16x32_bf16 v[184:187], v[24:27], v[200:203], v[184:187]
    v_mfma_f32_16x16x32_bf16 v[188:191], v[24:27], v[204:207], v[188:191]
    v_mfma_f32_16x16x32_bf16 v[192:195], v[24:27], v[208:211], v[192:195]
    s_waitcnt vmcnt(21) lgkmcnt(0)
    v_mfma_f32_16x16x32_bf16 v[148:151], v[28:31], v[212:215], v[148:151]
    ds_read_b128 v[228:231], v3 offset:8192
    v_mfma_f32_16x16x32_bf16 v[152:155], v[28:31], v[216:219], v[152:155]
    v_mfma_f32_16x16x32_bf16 v[156:159], v[28:31], v[220:223], v[156:159]
    ds_read_b128 v[232:235], v3 offset:9216
    v_mfma_f32_16x16x32_bf16 v[160:163], v[28:31], v[224:227], v[160:163]
    v_mfma_f32_16x16x32_bf16 v[164:167], v[32:35], v[212:215], v[164:167]
    ds_read_b128 v[236:239], v3 offset:10240
    v_mfma_f32_16x16x32_bf16 v[168:171], v[32:35], v[216:219], v[168:171]
    v_mfma_f32_16x16x32_bf16 v[172:175], v[32:35], v[220:223], v[172:175]
    ds_read_b128 v[240:243], v3 offset:11264
    v_mfma_f32_16x16x32_bf16 v[176:179], v[32:35], v[224:227], v[176:179]
    v_mfma_f32_16x16x32_bf16 v[180:183], v[36:39], v[212:215], v[180:183]
    v_mfma_f32_16x16x32_bf16 v[184:187], v[36:39], v[216:219], v[184:187]
    v_mfma_f32_16x16x32_bf16 v[188:191], v[36:39], v[220:223], v[188:191]
    v_mfma_f32_16x16x32_bf16 v[192:195], v[36:39], v[224:227], v[192:195]
    s_waitcnt vmcnt(18) lgkmcnt(0)
    v_mfma_f32_16x16x32_bf16 v[148:151], v[40:43], v[228:231], v[148:151]
    ds_read_b128 v[196:199], v3 offset:12288
    v_mfma_f32_16x16x32_bf16 v[152:155], v[40:43], v[232:235], v[152:155]
    v_mfma_f32_16x16x32_bf16 v[156:159], v[40:43], v[236:239], v[156:159]
    ds_read_b128 v[200:203], v3 offset:13312
    v_mfma_f32_16x16x32_bf16 v[160:163], v[40:43], v[240:243], v[160:163]
    v_mfma_f32_16x16x32_bf16 v[164:167], v[44:47], v[228:231], v[164:167]
    ds_read_b128 v[204:207], v3 offset:14336
    v_mfma_f32_16x16x32_bf16 v[168:171], v[44:47], v[232:235], v[168:171]
    v_mfma_f32_16x16x32_bf16 v[172:175], v[44:47], v[236:239], v[172:175]
    ds_read_b128 v[208:211], v3 offset:15360
    v_mfma_f32_16x16x32_bf16 v[176:179], v[44:47], v[240:243], v[176:179]
    v_mfma_f32_16x16x32_bf16 v[180:183], v[48:51], v[228:231], v[180:183]
    v_mfma_f32_16x16x32_bf16 v[184:187], v[48:51], v[232:235], v[184:187]
    v_mfma_f32_16x16x32_bf16 v[188:191], v[48:51], v[236:239], v[188:191]
    v_mfma_f32_16x16x32_bf16 v[192:195], v[48:51], v[240:243], v[192:195]
    s_waitcnt vmcnt(15) lgkmcnt(0)
    v_mfma_f32_16x16x32_bf16 v[148:151], v[52:55], v[196:199], v[148:151]
    ds_read_b128 v[212:215], v3 offset:16384
    v_mfma_f32_16x16x32_bf16 v[152:155], v[52:55], v[200:203], v[152:155]
    v_mfma_f32_16x16x32_bf16 v[156:159], v[52:55], v[204:207], v[156:159]
    ds_read_b128 v[216:219], v3 offset:17408
    v_mfma_f32_16x16x32_bf16 v[160:163], v[52:55], v[208:211], v[160:163]
    v_mfma_f32_16x16x32_bf16 v[164:167], v[56:59], v[196:199], v[164:167]
    ds_read_b128 v[220:223], v3 offset:18432
    v_mfma_f32_16x16x32_bf16 v[168:171], v[56:59], v[200:203], v[168:171]
    v_mfma_f32_16x16x32_bf16 v[172:175], v[56:59], v[204:207], v[172:175]
    ds_read_b128 v[224:227], v3 offset:19456
    v_mfma_f32_16x16x32_bf16 v[176:179], v[56:59], v[208:211], v[176:179]
    v_mfma_f32_16x16x32_bf16 v[180:183], v[60:63], v[196:199], v[180:183]
    v_mfma_f32_16x16x32_bf16 v[184:187], v[60:63], v[200:203], v[184:187]
    v_mfma_f32_16x16x32_bf16 v[188:191], v[60:63], v[204:207], v[188:191]
    v_mfma_f32_16x16x32_bf16 v[192:195], v[60:63], v[208:211], v[192:195]
    s_waitcnt vmcnt(12) lgkmcnt(0)
    v_mfma_f32_16x16x32_bf16 v[148:151], v[64:67], v[212:215], v[148:151]
    ds_read_b128 v[228:231], v3 offset:20480
    v_mfma_f32_16x16x32_bf16 v[152:155], v[64:67], v[216:219], v[152:155]
    v_mfma_f32_16x16x32_bf16 v[156:159], v[64:67], v[220:223], v[156:159]
    ds_read_b128 v[232:235], v3 offset:21504
    v_mfma_f32_16x16x32_bf16 v[160:163], v[64:67], v[224:227], v[160:163]
    v_mfma_f32_16x16x32_bf16 v[164:167], v[68:71], v[212:215], v[164:167]
    ds_read_b128 v[236:239], v3 offset:22528
    v_mfma_f32_16x16x32_bf16 v[168:171], v[68:71], v[216:219], v[168:171]
    v_mfma_f32_16x16x32_bf16 v[172:175], v[68:71], v[220:223], v[172:175]
    ds_read_b128 v[240:243], v3 offset:23552
    v_mfma_f32_16x16x32_bf16 v[176:179], v[68:71], v[224:227], v[176:179]
    v_mfma_f32_16x16x32_bf16 v[180:183], v[72:75], v[212:215], v[180:183]
    v_mfma_f32_16x16x32_bf16 v[184:187], v[72:75], v[216:219], v[184:187]
    v_mfma_f32_16x16x32_bf16 v[188:191], v[72:75], v[220:223], v[188:191]
    v_mfma_f32_16x16x32_bf16 v[192:195], v[72:75], v[224:227], v[192:195]
    s_waitcnt vmcnt(9) lgkmcnt(0)
    v_mfma_f32_16x16x32_bf16 v[148:151], v[76:79], v[228:231], v[148:151]
    ds_read_b128 v[196:199], v3 offset:24576
    v_mfma_f32_16x16x32_bf16 v[152:155], v[76:79], v[232:235], v[152:155]
    v_mfma_f32_16x16x32_bf16 v[156:159], v[76:79], v[236:239], v[156:159]
    ds_read_b128 v[200:203], v3 offset:25600
    v_mfma_f32_16x16x32_bf16 v[160:163], v[76:79], v[240:243], v[160:163]
    v_mfma_f32_16x16x32_bf16 v[164:167], v[80:83], v[228:231], v[164:167]
    ds_read_b128 v[204:207], v3 offset:26624
    v_mfma_f32_16x16x32_bf16 v[168:171], v[80:83], v[232:235], v[168:171]
    v_mfma_f32_16x16x32_bf16 v[172:175], v[80:83], v[236:239], v[172:175]
    ds_read_b128 v[208:211], v3 offset:27648
    v_mfma_f32_16x16x32_bf16 v[176:179], v[80:83], v[240:243], v[176:179]
    v_mfma_f32_16x16x32_bf16 v[180:183], v[84:87], v[228:231], v[180:183]
    v_mfma_f32_16x16x32_bf16 v[184:187], v[84:87], v[232:235], v[184:187]
    v_mfma_f32_16x16x32_bf16 v[188:191], v[84:87], v[236:239], v[188:191]
    v_mfma_f32_16x16x32_bf16 v[192:195], v[84:87], v[240:243], v[192:195]
    s_waitcnt vmcnt(6) lgkmcnt(0)
    v_mfma_f32_16x16x32_bf16 v[148:151], v[88:91], v[196:199], v[148:151]
    ds_read_b128 v[212:215], v3 offset:28672
    v_mfma_f32_16x16x32_bf16 v[152:155], v[88:91], v[200:203], v[152:155]
    v_mfma_f32_16x16x32_bf16 v[156:159], v[88:91], v[204:207], v[156:159]
    ds_read_b128 v[216:219], v3 offset:29696
    v_mfma_f32_16x16x32_bf16 v[160:163], v[88:91], v[208:211], v[160:163]
    v_mfma_f32_16x16x32_bf16 v[164:167], v[92:95], v[196:199], v[164:167]
    ds_read_b128 v[220:223], v3 offset:30720
    v_mfma_f32_16x16x32_bf16 v[168:171], v[92:95], v[200:203], v[168:171]
    v_mfma_f32_16x16x32_bf16 v[172:175], v[92:95], v[204:207], v[172:175]
    ds_read_b128 v[224:227], v3 offset:31744
    v_mfma_f32_16x16x32_bf16 v[176:179], v[92:95], v[208:211], v[176:179]
    v_mfma_f32_16x16x32_bf16 v[180:183], v[96:99], v[196:199], v[180:183]
    v_mfma_f32_16x16x32_bf16 v[184:187], v[96:99], v[200:203], v[184:187]
    v_mfma_f32_16x16x32_bf16 v[188:191], v[96:99], v[204:207], v[188:191]
    v_mfma_f32_16x16x32_bf16 v[192:195], v[96:99], v[208:211], v[192:195]
    s_waitcnt vmcnt(3) lgkmcnt(0)
    v_mfma_f32_16x16x32_bf16 v[148:151], v[100:103], v[212:215], v[148:151]
    ds_read_b128 v[228:231], v3 offset:32768
    v_mfma_f32_16x16x32_bf16 v[152:155], v[100:103], v[216:219], v[152:155]
    v_mfma_f32_16x16x32_bf16 v[156:159], v[100:103], v[220:223], v[156:159]
    ds_read_b128 v[232:235], v3 offset:33792
    v_mfma_f32_16x16x32_bf16 v[160:163], v[100:103], v[224:227], v[160:163]
    v_mfma_f32_16x16x32_bf16 v[164:167], v[104:107], v[212:215], v[164:167]
    ds_read_b128 v[236:239], v3 offset:34816
    v_mfma_f32_16x16x32_bf16 v[168:171], v[104:107], v[216:219], v[168:171]
    v_mfma_f32_16x16x32_bf16 v[172:175], v[104:107], v[220:223], v[172:175]
    ds_read_b128 v[240:243], v3 offset:35840
    v_mfma_f32_16x16x32_bf16 v[176:179], v[104:107], v[224:227], v[176:179]
    v_mfma_f32_16x16x32_bf16 v[180:183], v[108:111], v[212:215], v[180:183]
    v_mfma_f32_16x16x32_bf16 v[184:187], v[108:111], v[216:219], v[184:187]
    v_mfma_f32_16x16x32_bf16 v[188:191], v[108:111], v[220:223], v[188:191]
    v_mfma_f32_16x16x32_bf16 v[192:195], v[108:111], v[224:227], v[192:195]
    s_waitcnt vmcnt(0) lgkmcnt(0)
    v_mfma_f32_16x16x32_bf16 v[148:151], v[112:115], v[228:231], v[148:151]
    v_mfma_f32_16x16x32_bf16 v[152:155], v[112:115], v[232:235], v[152:155]
    v_mfma_f32_16x16x32_bf16 v[156:159], v[112:115], v[236:239], v[156:159]
    v_mfma_f32_16x16x32_bf16 v[160:163], v[112:115], v[240:243], v[160:163]
    v_mfma_f32_16x16x32_bf16 v[164:167], v[116:119], v[228:231], v[164:167]
    v_mfma_f32_16x16x32_bf16 v[168:171], v[116:119], v[232:235], v[168:171]
    v_mfma_f32_16x16x32_bf16 v[172:175], v[116:119], v[236:239], v[172:175]
    v_mfma_f32_16x16x32_bf16 v[176:179], v[116:119], v[240:243], v[176:179]
    v_mfma_f32_16x16x32_bf16 v[180:183], v[120:123], v[228:231], v[180:183]
    v_mfma_f32_16x16x32_bf16 v[184:187], v[120:123], v[232:235], v[184:187]
    v_mfma_f32_16x16x32_bf16 v[188:191], v[120:123], v[236:239], v[188:191]
    v_mfma_f32_16x16x32_bf16 v[192:195], v[120:123], v[240:243], v[192:195]
    s_mov_b32 s40, 6
Lepi:
    s_setprio 0
    s_add_u32 s28, s40, s41
    s_cmp_gt_u32 s28, 4
    s_cbranch_scc1 Lstore
    s_cmp_eq_u32 s28, 4
    s_cbranch_scc0 Lnox
    s_barrier
    s_setprio 0
Lnox:
    s_mul_i32 s29, s28, 6
    s_lshr_b32 s30, s43, 1
    s_add_u32 s29, s29, s30
    s_lshl_b32 s29, s29, 12
    s_and_b32 s30, s43, 1
    s_lshl3_add_u32 s29, s30, s29
    s_add_u32 s29, s29, 24576
    v_add_u32 v4, s29, v7
    v_mul_f32 v228, v148, v148
    v_mul_f32 v229, v149, v149
    v_mul_f32 v230, v150, v150
    v_mul_f32 v231, v151, v151
    v_fma_f32 v228, v228, v9, s44
    v_fma_f32 v229, v229, v9, s44
    v_fma_f32 v230, v230, v9, s44
    v_fma_f32 v231, v231, v9, s44
    v_mul_f32 v228, v228, v148
    v_mul_f32 v229, v229, v149
    v_mul_f32 v230, v230, v150
    v_mul_f32 v231, v231, v151
    v_exp_f32 v228, v228
    v_exp_f32 v229, v229
    v_exp_f32 v230, v230
    v_exp_f32 v231, v231
    v_add_f32 v228, 1.0, v228
    v_add_f32 v229, 1.0, v229
    v_add_f32 v230, 1.0, v230
    v_add_f32 v231, 1.0, v231
    v_rcp_f32 v228, v228
    v_rcp_f32 v229, v229
    v_rcp_f32 v230, v230
    v_rcp_f32 v231, v231
    v_mul_f32 v228, v228, v148
    v_mul_f32 v229, v229, v149
    v_mul_f32 v230, v230, v150
    v_mul_f32 v231, v231, v151
    v_cvt_pk_bf16_f32 v148, v228, v229
    v_cvt_pk_bf16_f32 v149, v230, v231
    ds_write_b64 v4, v[148:149] offset:0
    v_mul_f32 v232, v152, v152
    v_mul_f32 v233, v153, v153
    v_mul_f32 v234, v154, v154
    v_mul_f32 v235, v155, v155
    v_fma_f32 v232, v232, v9, s44
    v_fma_f32 v233, v233, v9, s44
    v_fma_f32 v234, v234, v9, s44
    v_fma_f32 v235, v235, v9, s44
    v_mul_f32 v232, v232, v152
    v_mul_f32 v233, v233, v153
    v_mul_f32 v234, v234, v154
    v_mul_f32 v235, v235, v155
    v_exp_f32 v232, v232
    v_exp_f32 v233, v233
    v_exp_f32 v234, v234
    v_exp_f32 v235, v235
    v_add_f32 v232, 1.0, v232
    v_add_f32 v233, 1.0, v233
    v_add_f32 v234, 1.0, v234
    v_add_f32 v235, 1.0, v235
    v_rcp_f32 v232, v232
    v_rcp_f32 v233, v233
    v_rcp_f32 v234, v234
    v_rcp_f32 v235, v235
    v_mul_f32 v232, v232, v152
    v_mul_f32 v233, v233, v153
    v_mul_f32 v234, v234, v154
    v_mul_f32 v235, v235, v155
    v_cvt_pk_bf16_f32 v152, v232, v233
    v_cvt_pk_bf16_f32 v153, v234, v235
    ds_write_b64 v4, v[152:153] offset:1024
    v_mul_f32 v228, v156, v156
    v_mul_f32 v229, v157, v157
    v_mul_f32 v230, v158, v158
    v_mul_f32 v231, v159, v159
    v_fma_f32 v228, v228, v9, s44
    v_fma_f32 v229, v229, v9, s44
    v_fma_f32 v230, v230, v9, s44
    v_fma_f32 v231, v231, v9, s44
    v_mul_f32 v228, v228, v156
    v_mul_f32 v229, v229, v157
    v_mul_f32 v230, v230, v158
    v_mul_f32 v231, v231, v159
    v_exp_f32 v228, v228
    v_exp_f32 v229, v229
    v_exp_f32 v230, v230
    v_exp_f32 v231, v231
    v_add_f32 v228, 1.0, v228
    v_add_f32 v229, 1.0, v229
    v_add_f32 v230, 1.0, v230
    v_add_f32 v231, 1.0, v231
    v_rcp_f32 v228, v228
    v_rcp_f32 v229, v229
    v_rcp_f32 v230, v230
    v_rcp_f32 v231, v231
    v_mul_f32 v228, v228, v156
    v_mul_f32 v229, v229, v157
    v_mul_f32 v230, v230, v158
    v_mul_f32 v231, v231, v159
    v_cvt_pk_bf16_f32 v156, v228, v229
    v_cvt_pk_bf16_f32 v157, v230, v231
    ds_write_b64 v4, v[156:157] offset:2048
    v_mul_f32 v232, v160, v160
    v_mul_f32 v233, v161, v161
    v_mul_f32 v234, v162, v162
    v_mul_f32 v235, v163, v163
    v_fma_f32 v232, v232, v9, s44
    v_fma_f32 v233, v233, v9, s44
    v_fma_f32 v234, v234, v9, s44
    v_fma_f32 v235, v235, v9, s44
    v_mul_f32 v232, v232, v160
    v_mul_f32 v233, v233, v161
    v_mul_f32 v234, v234, v162
    v_mul_f32 v235, v235, v163
    v_exp_f32 v232, v232
    v_exp_f32 v233, v233
    v_exp_f32 v234, v234
    v_exp_f32 v235, v235
    v_add_f32 v232, 1.0, v232
    v_add_f32 v233, 1.0, v233
    v_add_f32 v234, 1.0, v234
    v_add_f32 v235, 1.0, v235
    v_rcp_f32 v232, v232
    v_rcp_f32 v233, v233
    v_rcp_f32 v234, v234
    v_rcp_f32 v235, v235
    v_mul_f32 v232, v232, v160
    v_mul_f32 v233, v233, v161
    v_mul_f32 v234, v234, v162
    v_mul_f32 v235, v235, v163
    v_cvt_pk_bf16_f32 v160, v232, v233
    v_cvt_pk_bf16_f32 v161, v234, v235
    ds_write_b64 v4, v[160:161] offset:3072
    v_mul_f32 v228, v164, v164
    v_mul_f32 v229, v165, v165
    v_mul_f32 v230, v166, v166
    v_mul_f32 v231, v167, v167
    v_fma_f32 v228, v228, v9, s44
    v_fma_f32 v229, v229, v9, s44
    v_fma_f32 v230, v230, v9, s44
    v_fma_f32 v231, v231, v9, s44
    v_mul_f32 v228, v228, v164
    v_mul_f32 v229, v229, v165
    v_mul_f32 v230, v230, v166
    v_mul_f32 v231, v231, v167
    v_exp_f32 v228, v228
    v_exp_f32 v229, v229
    v_exp_f32 v230, v230
    v_exp_f32 v231, v231
    v_add_f32 v228, 1.0, v228
    v_add_f32 v229, 1.0, v229
    v_add_f32 v230, 1.0, v230
    v_add_f32 v231, 1.0, v231
    v_rcp_f32 v228, v228
    v_rcp_f32 v229, v229
    v_rcp_f32 v230, v230
    v_rcp_f32 v231, v231
    v_mul_f32 v228, v228, v164
    v_mul_f32 v229, v229, v165
    v_mul_f32 v230, v230, v166
    v_mul_f32 v231, v231, v167
    v_cvt_pk_bf16_f32 v164, v228, v229
    v_cvt_pk_bf16_f32 v165, v230, v231
    ds_write_b64 v4, v[164:165] offset:8192
    v_mul_f32 v232, v168, v168
    v_mul_f32 v233, v169, v169
    v_mul_f32 v234, v170, v170
    v_mul_f32 v235, v171, v171
    v_fma_f32 v232, v232, v9, s44
    v_fma_f32 v233, v233, v9, s44
    v_fma_f32 v234, v234, v9, s44
    v_fma_f32 v235, v235, v9, s44
    v_mul_f32 v232, v232, v168
    v_mul_f32 v233, v233, v169
    v_mul_f32 v234, v234, v170
    v_mul_f32 v235, v235, v171
    v_exp_f32 v232, v232
    v_exp_f32 v233, v233
    v_exp_f32 v234, v234
    v_exp_f32 v235, v235
    v_add_f32 v232, 1.0, v232
    v_add_f32 v233, 1.0, v233
    v_add_f32 v234, 1.0, v234
    v_add_f32 v235, 1.0, v235
    v_rcp_f32 v232, v232
    v_rcp_f32 v233, v233
    v_rcp_f32 v234, v234
    v_rcp_f32 v235, v235
    v_mul_f32 v232, v232, v168
    v_mul_f32 v233, v233, v169
    v_mul_f32 v234, v234, v170
    v_mul_f32 v235, v235, v171
    v_cvt_pk_bf16_f32 v168, v232, v233
    v_cvt_pk_bf16_f32 v169, v234, v235
    ds_write_b64 v4, v[168:169] offset:9216
    v_mul_f32 v228, v172, v172
    v_mul_f32 v229, v173, v173
    v_mul_f32 v230, v174, v174
    v_mul_f32 v231, v175, v175
    v_fma_f32 v228, v228, v9, s44
    v_fma_f32 v229, v229, v9, s44
    v_fma_f32 v230, v230, v9, s44
    v_fma_f32 v231, v231, v9, s44
    v_mul_f32 v228, v228, v172
    v_mul_f32 v229, v229, v173
    v_mul_f32 v230, v230, v174
    v_mul_f32 v231, v231, v175
    v_exp_f32 v228, v228
    v_exp_f32 v229, v229
    v_exp_f32 v230, v230
    v_exp_f32 v231, v231
    v_add_f32 v228, 1.0, v228
    v_add_f32 v229, 1.0, v229
    v_add_f32 v230, 1.0, v230
    v_add_f32 v231, 1.0, v231
    v_rcp_f32 v228, v228
    v_rcp_f32 v229, v229
    v_rcp_f32 v230, v230
    v_rcp_f32 v231, v231
    v_mul_f32 v228, v228, v172
    v_mul_f32 v229, v229, v173
    v_mul_f32 v230, v230, v174
    v_mul_f32 v231, v231, v175
    v_cvt_pk_bf16_f32 v172, v228, v229
    v_cvt_pk_bf16_f32 v173, v230, v231
    ds_write_b64 v4, v[172:173] offset:10240
    v_mul_f32 v232, v176, v176
    v_mul_f32 v233, v177, v177
    v_mul_f32 v234, v178, v178
    v_mul_f32 v235, v179, v179
    v_fma_f32 v232, v232, v9, s44
    v_fma_f32 v233, v233, v9, s44
    v_fma_f32 v234, v234, v9, s44
    v_fma_f32 v235, v235, v9, s44
    v_mul_f32 v232, v232, v176
    v_mul_f32 v233, v233, v177
    v_mul_f32 v234, v234, v178
    v_mul_f32 v235, v235, v179
    v_exp_f32 v232, v232
    v_exp_f32 v233, v233
    v_exp_f32 v234, v234
    v_exp_f32 v235, v235
    v_add_f32 v232, 1.0, v232
    v_add_f32 v233, 1.0, v233
    v_add_f32 v234, 1.0, v234
    v_add_f32 v235, 1.0, v235
    v_rcp_f32 v232, v232
    v_rcp_f32 v233, v233
    v_rcp_f32 v234, v234
    v_rcp_f32 v235, v235
    v_mul_f32 v232, v232, v176
    v_mul_f32 v233, v233, v177
    v_mul_f32 v234, v234, v178
    v_mul_f32 v235, v235, v179
    v_cvt_pk_bf16_f32 v176, v232, v233
    v_cvt_pk_bf16_f32 v177, v234, v235
    ds_write_b64 v4, v[176:177] offset:11264
    s_cmp_eq_u32 s28, 4
    s_cbranch_scc0 Lnoy
    s_waitcnt lgkmcnt(0)
    s_barrier
Lnoy:
    v_mul_f32 v228, v180, v180
    v_mul_f32 v229, v181, v181
    v_mul_f32 v230, v182, v182
    v_mul_f32 v231, v183, v183
    v_fma_f32 v228, v228, v9, s44
    v_fma_f32 v229, v229, v9, s44
    v_fma_f32 v230, v230, v9, s44
    v_fma_f32 v231, v231, v9, s44
    v_mul_f32 v228, v228, v180
    v_mul_f32 v229, v229, v181
    v_mul_f32 v230, v230, v182
    v_mul_f32 v231, v231, v183
    v_exp_f32 v228, v228
    v_exp_f32 v229, v229
    v_exp_f32 v230, v230
    v_exp_f32 v231, v231
    v_add_f32 v228, 1.0, v228
    v_add_f32 v229, 1.0, v229
    v_add_f32 v230, 1.0, v230
    v_add_f32 v231, 1.0, v231
    v_rcp_f32 v228, v228
    v_rcp_f32 v229, v229
    v_rcp_f32 v230, v230
    v_rcp_f32 v231, v231
    v_mul_f32 v228, v228, v180
    v_mul_f32 v229, v229, v181
    v_mul_f32 v230, v230, v182
    v_mul_f32 v231, v231, v183
    v_cvt_pk_bf16_f32 v180, v228, v229
    v_cvt_pk_bf16_f32 v181, v230, v231
    ds_write_b64 v4, v[180:181] offset:16384
    v_mul_f32 v232, v184, v184
    v_mul_f32 v233, v185, v185
    v_mul_f32 v234, v186, v186
    v_mul_f32 v235, v187, v187
    v_fma_f32 v232, v232, v9, s44
    v_fma_f32 v233, v233, v9, s44
    v_fma_f32 v234, v234, v9, s44
    v_fma_f32 v235, v235, v9, s44
    v_mul_f32 v232, v232, v184
    v_mul_f32 v233, v233, v185
    v_mul_f32 v234, v234, v186
    v_mul_f32 v235, v235, v187
    v_exp_f32 v232, v232
    v_exp_f32 v233, v233
    v_exp_f32 v234, v234
    v_exp_f32 v235, v235
    v_add_f32 v232, 1.0, v232
    v_add_f32 v233, 1.0, v233
    v_add_f32 v234, 1.0, v234
    v_add_f32 v235, 1.0, v235
    v_rcp_f32 v232, v232
    v_rcp_f32 v233, v233
    v_rcp_f32 v234, v234
    v_rcp_f32 v235, v235
    v_mul_f32 v232, v232, v184
    v_mul_f32 v233, v233, v185
    v_mul_f32 v234, v234, v186
    v_mul_f32 v235, v235, v187
    v_cvt_pk_bf16_f32 v184, v232, v233
    v_cvt_pk_bf16_f32 v185, v234, v235
    ds_write_b64 v4, v[184:185] offset:17408
    v_mul_f32 v228, v188, v188
    v_mul_f32 v229, v189, v189
    v_mul_f32 v230, v190, v190
    v_mul_f32 v231, v191, v191
    v_fma_f32 v228, v228, v9, s44
    v_fma_f32 v229, v229, v9, s44
    v_fma_f32 v230, v230, v9, s44
    v_fma_f32 v231, v231, v9, s44
    v_mul_f32 v228, v228, v188
    v_mul_f32 v229, v229, v189
    v_mul_f32 v230, v230, v190
    v_mul_f32 v231, v231, v191
    v_exp_f32 v228, v228
    v_exp_f32 v229, v229
    v_exp_f32 v230, v230
    v_exp_f32 v231, v231
    v_add_f32 v228, 1.0, v228
    v_add_f32 v229, 1.0, v229
    v_add_f32 v230, 1.0, v230
    v_add_f32 v231, 1.0, v231
    v_rcp_f32 v228, v228
    v_rcp_f32 v229, v229
    v_rcp_f32 v230, v230
    v_rcp_f32 v231, v231
    v_mul_f32 v228, v228, v188
    v_mul_f32 v229, v229, v189
    v_mul_f32 v230, v230, v190
    v_mul_f32 v231, v231, v191
    v_cvt_pk_bf16_f32 v188, v228, v229
    v_cvt_pk_bf16_f32 v189, v230, v231
    ds_write_b64 v4, v[188:189] offset:18432
    v_mul_f32 v232, v192, v192
    v_mul_f32 v233, v193, v193
    v_mul_f32 v234, v194, v194
    v_mul_f32 v235, v195, v195
    v_fma_f32 v232, v232, v9, s44
    v_fma_f32 v233, v233, v9, s44
    v_fma_f32 v234, v234, v9, s44
    v_fma_f32 v235, v235, v9, s44
    v_mul_f32 v232, v232, v192
    v_mul_f32 v233, v233, v193
    v_mul_f32 v234, v234, v194
    v_mul_f32 v235, v235, v195
    v_exp_f32 v232, v232
    v_exp_f32 v233, v233
    v_exp_f32 v234, v234
    v_exp_f32 v235, v235
    v_add_f32 v232, 1.0, v232
    v_add_f32 v233, 1.0, v233
    v_add_f32 v234, 1.0, v234
    v_add_f32 v235, 1.0, v235
    v_rcp_f32 v232, v232
    v_rcp_f32 v233, v233
    v_rcp_f32 v234, v234
    v_rcp_f32 v235, v235
    v_mul_f32 v232, v232, v192
    v_mul_f32 v233, v233, v193
    v_mul_f32 v234, v234, v194
    v_mul_f32 v235, v235, v195
    v_cvt_pk_bf16_f32 v192, v232, v233
    v_cvt_pk_bf16_f32 v193, v234, v235
    ds_write_b64 v4, v[192:193] offset:19456
    s_cmp_eq_u32 s28, 2
    s_cbranch_scc0 Lg2
    v_mov_b32 v3, v7
    s_waitcnt lgkmcnt(0)
    v_mov_b32 v124, v136
    v_mov_b32 v125, v137
    v_mov_b32 v126, v138
    v_mov_b32 v127, v139
    v_mov_b32 v128, v140
    v_mov_b32 v129, v141
    v_mov_b32 v130, v142
    v_mov_b32 v131, v143
    v_mov_b32 v132, v144
    v_mov_b32 v133, v145
    v_mov_b32 v134, v146
    v_mov_b32 v135, v147
    s_branch Lphase
Lg2:
    s_waitcnt lgkmcnt(0)
    s_cmp_eq_u32 s28, 4
    s_cbranch_scc0 Lg2b
    s_barrier
Lg2b:
    v_add_u32 v3, 73728, v7
    v_mov_b32 v124, 0
    v_mov_b32 v125, 0
    v_mov_b32 v126, 0
    v_mov_b32 v127, 0
    v_mov_b32 v128, 0
    v_mov_b32 v129, 0
    v_mov_b32 v130, 0
    v_mov_b32 v131, 0
    v_mov_b32 v132, 0
    v_mov_b32 v133, 0
    v_mov_b32 v134, 0
    v_mov_b32 v135, 0
    s_cbranch_scc1 Lphase
    s_barrier
    s_branch Lphase
Lstore:
    s_sub_u32 s31, s28, 5
    s_mul_i32 s29, s31, 6144
    s_add_u32 s29, s29, s45
    s_add_u32 s30, s29, 4096
    s_waitcnt lgkmcnt(0)
    s_cmp_eq_u32 s28, 7
    v_cvt_pk_bf16_f32 v212, v148, v149
    v_cvt_pk_bf16_f32 v213, v150, v151
    v_cvt_pk_bf16_f32 v214, v152, v153
    v_cvt_pk_bf16_f32 v215, v154, v155
    s_cbranch_scc0 Lsb0
    buffer_store_dwordx4 v[212:215], v7, s[12:15], s29 offen offset:0 sc1
Lsb0:
    v_cvt_pk_bf16_f32 v216, v156, v157
    v_cvt_pk_bf16_f32 v217, v158, v159
    v_cvt_pk_bf16_f32 v218, v160, v161
    v_cvt_pk_bf16_f32 v219, v162, v163
    s_cbranch_scc0 Lsb1
    buffer_store_dwordx4 v[216:219], v7, s[12:15], s29 offen offset:1024 sc1
Lsb1:
    v_cvt_pk_bf16_f32 v220, v164, v165
    v_cvt_pk_bf16_f32 v221, v166, v167
    v_cvt_pk_bf16_f32 v222, v168, v169
    v_cvt_pk_bf16_f32 v223, v170, v171
    s_cbranch_scc0 Lsb2
    buffer_store_dwordx4 v[220:223], v7, s[12:15], s29 offen offset:2048 sc1
Lsb2:
    v_cvt_pk_bf16_f32 v224, v172, v173
    v_cvt_pk_bf16_f32 v225, v174, v175
    v_cvt_pk_bf16_f32 v226, v176, v177
    v_cvt_pk_bf16_f32 v227, v178, v179
    s_cbranch_scc0 Lsb3
    buffer_store_dwordx4 v[224:227], v7, s[12:15], s29 offen offset:3072 sc1
Lsb3:
    v_cvt_pk_bf16_f32 v228, v180, v181
    v_cvt_pk_bf16_f32 v229, v182, v183
    v_cvt_pk_bf16_f32 v230, v184, v185
    v_cvt_pk_bf16_f32 v231, v186, v187
    s_cbranch_scc0 Lsb4
    buffer_store_dwordx4 v[228:231], v7, s[12:15], s30 offen offset:0 sc1
Lsb4:
    v_cvt_pk_bf16_f32 v232, v188, v189
    v_cvt_pk_bf16_f32 v233, v190, v191
    v_cvt_pk_bf16_f32 v234, v192, v193
    v_cvt_pk_bf16_f32 v235, v194, v195
    s_cbranch_scc0 Lsb5
    buffer_store_dwordx4 v[232:235], v7, s[12:15], s30 offen offset:1024 sc1
Lsb5:
    s_cbranch_scc1 Lsb7
    v_add_u32 v3, 73728, v7
    s_barrier
    buffer_store_dwordx4 v[212:215], v7, s[12:15], s29 offen offset:0 sc1
    buffer_store_dwordx4 v[216:219], v7, s[12:15], s29 offen offset:1024 sc1
    buffer_store_dwordx4 v[220:223], v7, s[12:15], s29 offen offset:2048 sc1
    buffer_store_dwordx4 v[224:227], v7, s[12:15], s29 offen offset:3072 sc1
    buffer_store_dwordx4 v[228:231], v7, s[12:15], s30 offen offset:0 sc1
    buffer_store_dwordx4 v[232:235], v7, s[12:15], s30 offen offset:1024 sc1
Lsb7:
    s_cmp_eq_u32 s28, 5
    s_cbranch_scc1 Lphase
    s_load_dwordx4 s[4:7], s[0:1], 56
    s_lshl_b32 s28, s41, 1
    s_add_u32 s24, s24, s28
    s_add_u32 s61, s61, s28
    v_and_b32 v10, 7, v1
    v_mul_u32_u24 v8, 73728, v10
    v_lshrrev_b32 v11, 4, v1
    v_lshlrev_b32 v11, 3, v11
    v_and_b32 v2, 31, v1
    v_mul_u32_u24 v2, 1152, v2
    v_lshrrev_b32 v3, 5, v1
    v_lshl_add_u32 v2, v3, 4, v2
    s_mov_b32 s34, 0x00003f80
    s_mov_b32 s35, 0x3f800000
    s_waitcnt lgkmcnt(0)
    s_mov_b32 s20, s4
    s_mov_b32 s21, s5
    s_mov_b32 s22, 0x480
    s_mov_b32 s23, 0x20000
    s_mov_b32 s16, s6
    s_mov_b32 s17, s7
    s_mov_b32 s18, 0x240000
    s_mov_b32 s19, 0x20000
    s_cmp_eq_u32 s43, 3
    s_cbranch_scc0 Lred
    s_cmp_eq_u32 s41, 0
    s_cbranch_scc0 Lend
    s_waitcnt vmcnt(0)
    s_mov_b64 exec, 3
    v_mov_b32 v0, 1
    v_lshlrev_b32 v251, 14, v1
    buffer_store_dword v0, v251, s[12:15], s46 offen sc1
    s_mov_b64 exec, -1
    s_branch Lend
Lred:
    s_lshl_b32 s30, s24, 10
    s_add_u32 s30, s30, 147456
    v_add_u32 v3, s30, v7
    s_lshl_b32 s31, s61, 5
    ds_read_b128 v[16:19], v3
    buffer_load_dwordx2 v[20:21], v11, s[20:23], s31 offen
    s_mul_i32 s30, s52, 589824
    s_lshl_b32 s32, s61, 1
    s_add_u32 s32, s32, s53
    s_lshl_b32 s32, s32, 10
    s_add_u32 s30, s30, s32
    s_add_u32 s30, s30, 33554432
    s_mul_i32 s32, s51, 36864
    s_add_u32 s31, s31, s32
    s_cmp_eq_u32 s41, 0
    s_cbranch_scc1 LrA
    s_mov_b32 s36, 0x1ff
    s_mov_b32 s84, 0x4000
Lr0:
    s_mov_b32 s32, s30
    s_bitcmp1_b32 s36, 0
    s_cbranch_scc0 Lr00
    buffer_load_dwordx4 v[32:35], v7, s[12:15], s32 offen sc1
Lr00:
    s_add_u32 s32, s32, 73728
    s_bitcmp1_b32 s36, 1
    s_cbranch_scc0 Lr01
    buffer_load_dwordx4 v[36:39], v7, s[12:15], s32 offen sc1
Lr01:
    s_add_u32 s32, s32, 73728
    s_bitcmp1_b32 s36, 2
    s_cbranch_scc0 Lr02
    buffer_load_dwordx4 v[40:43], v7, s[12:15], s32 offen sc1
Lr02:
    s_add_u32 s32, s32, 73728
    s_bitcmp1_b32 s36, 3
    s_cbranch_scc0 Lr03
    buffer_load_dwordx4 v[44:47], v7, s[12:15], s32 offen sc1
Lr03:
    s_add_u32 s32, s32, 73728
    s_bitcmp1_b32 s36, 4
    s_cbranch_scc0 Lr04
    buffer_load_dwordx4 v[48:51], v7, s[12:15], s32 offen sc1
Lr04:
    s_add_u32 s32, s32, 73728
    s_bitcmp1_b32 s36, 5
    s_cbranch_scc0 Lr05
    buffer_load_dwordx4 v[52:55], v7, s[12:15], s32 offen sc1
Lr05:
    s_add_u32 s32, s32, 73728
    s_bitcmp1_b32 s36, 6
    s_cbranch_scc0 Lr06
    buffer_load_dwordx4 v[56:59], v7, s[12:15], s32 offen sc1
Lr06:
    s_add_u32 s32, s32, 73728
    s_bitcmp1_b32 s36, 7
    s_cbranch_scc0 Lr07
    buffer_load_dwordx4 v[60:63], v7, s[12:15], s32 offen sc1
Lr07:
    s_bitcmp1_b32 s36, 8
    s_cbranch_scc0 Lr1
    s_bitset0_b32 s36, 8
    s_waitcnt vmcnt(8) lgkmcnt(0)
    v_lshlrev_b32 v24, 16, v16
    v_and_b32 v25, s38, v16
    v_lshlrev_b32 v26, 16, v17
    v_and_b32 v27, s38, v17
    v_lshlrev_b32 v28, 16, v18
    v_and_b32 v29, s38, v18
    v_lshlrev_b32 v30, 16, v19
    v_and_b32 v31, s38, v19
    v_dot2c_f32_bf16 v24, s34, v20
    v_dot2c_f32_bf16 v25, s35, v20
    v_dot2c_f32_bf16 v26, s34, v21
    v_dot2c_f32_bf16 v27, s35, v21
    v_dot2c_f32_bf16 v28, s34, v20
    v_dot2c_f32_bf16 v29, s35, v20
    v_dot2c_f32_bf16 v30, s34, v21
    v_dot2c_f32_bf16 v31, s35, v21
    v_permlane32_swap_b32 v24, v26
    v_permlane32_swap_b32 v25, v27
    v_permlane32_swap_b32 v28, v30
    v_permlane32_swap_b32 v29, v31
    v_permlane16_swap_b32 v24, v25
    v_permlane16_swap_b32 v26, v27
    v_permlane16_swap_b32 v28, v29
    v_permlane16_swap_b32 v30, v31
    s_branch Lr2
Lr1:
    s_waitcnt vmcnt(0)
Lr2:
    s_bitcmp1_b32 s36, 0
    s_cbranch_scc0 Lr20
    s_waitcnt vmcnt(7)
    v_max3_u32 v9, v32, v33, v34
    v_max_u32 v9, v9, v35
    v_cmp_eq_u32 vcc, -1, v9
    s_cbranch_vccnz Lr20
    s_bitset0_b32 s36, 0
    v_dot2c_f32_bf16 v24, s34, v32
    v_dot2c_f32_bf16 v25, s35, v32
    v_dot2c_f32_bf16 v26, s34, v33
    v_dot2c_f32_bf16 v27, s35, v33
    v_dot2c_f32_bf16 v28, s34, v34
    v_dot2c_f32_bf16 v29, s35, v34
    v_dot2c_f32_bf16 v30, s34, v35
    v_dot2c_f32_bf16 v31, s35, v35
Lr20:
    s_bitcmp1_b32 s36, 1
    s_cbranch_scc0 Lr21
    s_waitcnt vmcnt(6)
    v_max3_u32 v9, v36, v37, v38
    v_max_u32 v9, v9, v39
    v_cmp_eq_u32 vcc, -1, v9
    s_cbranch_vccnz Lr21
    s_bitset0_b32 s36, 1
    v_dot2c_f32_bf16 v24, s34, v36
    v_dot2c_f32_bf16 v25, s35, v36
    v_dot2c_f32_bf16 v26, s34, v37
    v_dot2c_f32_bf16 v27, s35, v37
    v_dot2c_f32_bf16 v28, s34, v38
    v_dot2c_f32_bf16 v29, s35, v38
    v_dot2c_f32_bf16 v30, s34, v39
    v_dot2c_f32_bf16 v31, s35, v39
Lr21:
    s_bitcmp1_b32 s36, 2
    s_cbranch_scc0 Lr22
    s_waitcnt vmcnt(5)
    v_max3_u32 v9, v40, v41, v42
    v_max_u32 v9, v9, v43
    v_cmp_eq_u32 vcc, -1, v9
    s_cbranch_vccnz Lr22
    s_bitset0_b32 s36, 2
    v_dot2c_f32_bf16 v24, s34, v40
    v_dot2c_f32_bf16 v25, s35, v40
    v_dot2c_f32_bf16 v26, s34, v41
    v_dot2c_f32_bf16 v27, s35, v41
    v_dot2c_f32_bf16 v28, s34, v42
    v_dot2c_f32_bf16 v29, s35, v42
    v_dot2c_f32_bf16 v30, s34, v43
    v_dot2c_f32_bf16 v31, s35, v43
Lr22:
    s_bitcmp1_b32 s36, 3
    s_cbranch_scc0 Lr23
    s_waitcnt vmcnt(4)
    v_max3_u32 v9, v44, v45, v46
    v_max_u32 v9, v9, v47
    v_cmp_eq_u32 vcc, -1, v9
    s_cbranch_vccnz Lr23
    s_bitset0_b32 s36, 3
    v_dot2c_f32_bf16 v24, s34, v44
    v_dot2c_f32_bf16 v25, s35, v44
    v_dot2c_f32_bf16 v26, s34, v45
    v_dot2c_f32_bf16 v27, s35, v45
    v_dot2c_f32_bf16 v28, s34, v46
    v_dot2c_f32_bf16 v29, s35, v46
    v_dot2c_f32_bf16 v30, s34, v47
    v_dot2c_f32_bf16 v31, s35, v47
Lr23:
    s_bitcmp1_b32 s36, 4
    s_cbranch_scc0 Lr24
    s_waitcnt vmcnt(3)
    v_max3_u32 v9, v48, v49, v50
    v_max_u32 v9, v9, v51
    v_cmp_eq_u32 vcc, -1, v9
    s_cbranch_vccnz Lr24
    s_bitset0_b32 s36, 4
    v_dot2c_f32_bf16 v24, s34, v48
    v_dot2c_f32_bf16 v25, s35, v48
    v_dot2c_f32_bf16 v26, s34, v49
    v_dot2c_f32_bf16 v27, s35, v49
    v_dot2c_f32_bf16 v28, s34, v50
    v_dot2c_f32_bf16 v29, s35, v50
    v_dot2c_f32_bf16 v30, s34, v51
    v_dot2c_f32_bf16 v31, s35, v51
Lr24:
    s_bitcmp1_b32 s36, 5
    s_cbranch_scc0 Lr25
    s_waitcnt vmcnt(2)
    v_max3_u32 v9, v52, v53, v54
    v_max_u32 v9, v9, v55
    v_cmp_eq_u32 vcc, -1, v9
    s_cbranch_vccnz Lr25
    s_bitset0_b32 s36, 5
    v_dot2c_f32_bf16 v24, s34, v52
    v_dot2c_f32_bf16 v25, s35, v52
    v_dot2c_f32_bf16 v26, s34, v53
    v_dot2c_f32_bf16 v27, s35, v53
    v_dot2c_f32_bf16 v28, s34, v54
    v_dot2c_f32_bf16 v29, s35, v54
    v_dot2c_f32_bf16 v30, s34, v55
    v_dot2c_f32_bf16 v31, s35, v55
Lr25:
    s_bitcmp1_b32 s36, 6
    s_cbranch_scc0 Lr26
    s_waitcnt vmcnt(1)
    v_max3_u32 v9, v56, v57, v58
    v_max_u32 v9, v9, v59
    v_cmp_eq_u32 vcc, -1, v9
    s_cbranch_vccnz Lr26
    s_bitset0_b32 s36, 6
    v_dot2c_f32_bf16 v24, s34, v56
    v_dot2c_f32_bf16 v25, s35, v56
    v_dot2c_f32_bf16 v26, s34, v57
    v_dot2c_f32_bf16 v27, s35, v57
    v_dot2c_f32_bf16 v28, s34, v58
    v_dot2c_f32_bf16 v29, s35, v58
    v_dot2c_f32_bf16 v30, s34, v59
    v_dot2c_f32_bf16 v31, s35, v59
Lr26:
    s_bitcmp1_b32 s36, 7
    s_cbranch_scc0 Lr27
    s_waitcnt vmcnt(0)
    v_max3_u32 v9, v60, v61, v62
    v_max_u32 v9, v9, v63
    v_cmp_eq_u32 vcc, -1, v9
    s_cbranch_vccnz Lr27
    s_bitset0_b32 s36, 7
    v_dot2c_f32_bf16 v24, s34, v60
    v_dot2c_f32_bf16 v25, s35, v60
    v_dot2c_f32_bf16 v26, s34, v61
    v_dot2c_f32_bf16 v27, s35, v61
    v_dot2c_f32_bf16 v28, s34, v62
    v_dot2c_f32_bf16 v29, s35, v62
    v_dot2c_f32_bf16 v30, s34, v63
    v_dot2c_f32_bf16 v31, s35, v63
Lr27:
    s_bcnt1_i32_b32 s33, s36
    s_cbranch_scc0 Lr4
Lr3:
    s_sub_u32 s84, s84, 1
    s_cbranch_scc1 Lr5
    s_cmp_le_u32 s33, 1
    s_cbranch_scc1 Lr0
    buffer_load_dword v9, v8, s[12:15], s30 offen offset:1020 sc1
    s_waitcnt vmcnt(0)
    v_cmp_eq_u32 vcc, -1, v9
    s_and_b32 s33, vcc_lo, 0xff
    s_bcnt1_i32_b32 s33, s33
    s_branch Lr3
Lr5:
    v_mov_b32 v24, -1
    v_mov_b32 v25, -1
    v_mov_b32 v26, -1
    v_mov_b32 v27, -1
    v_mov_b32 v28, -1
    v_mov_b32 v29, -1
    v_mov_b32 v30, -1
    v_mov_b32 v31, -1
Lr4:
    v_permlane32_swap_b32 v24, v26
    v_permlane32_swap_b32 v25, v27
    v_permlane32_swap_b32 v28, v30
    v_permlane32_swap_b32 v29, v31
    v_permlane16_swap_b32 v24, v25
    v_permlane16_swap_b32 v26, v27
    v_permlane16_swap_b32 v28, v29
    v_permlane16_swap_b32 v30, v31
    v_cvt_pk_bf16_f32 v24, v24, v25
    v_cvt_pk_bf16_f32 v25, v26, v27
    v_cvt_pk_bf16_f32 v26, v28, v29
    v_cvt_pk_bf16_f32 v27, v30, v31
    s_nop 0
    v_permlane16_swap_b32 v24, v26
    v_permlane16_swap_b32 v25, v27
    buffer_store_dwordx4 v[24:27], v2, s[16:19], s31 offen offset:0
Lend:
    s_endpgm
LrA:
    s_lshl_b32 s33, s61, 5
    ds_read_b128 v[104:107], v3 offset:3072
    buffer_load_dwordx2 v[22:23], v11, s[20:23], s33 offen offset:96
    s_lshl2_add_u32 s29, s52, s50
    s_lshl_b32 s29, s29, 7
    s_add_u32 s29, s29, 54542336
    s_mul_i32 s36, s53, 16384
    s_sub_u32 s29, s29, s36
    v_lshlrev_b32 v10, 2, v10
    v_add_u32 v8, 6144, v7
    buffer_load_dword v9, v10, s[12:15], s29 offen sc1
    s_mov_b32 s36, 0xff
    s_mov_b32 s84, 0x4000
    s_waitcnt vmcnt(3)
    s_mov_b64 exec, 3
    v_mov_b32 v0, 1
    v_lshlrev_b32 v251, 14, v1
    buffer_store_dword v0, v251, s[12:15], s46 offen sc1
    s_mov_b64 exec, -1
    s_waitcnt vmcnt(2) lgkmcnt(0)
    v_lshlrev_b32 v24, 16, v16
    v_and_b32 v25, s38, v16
    v_lshlrev_b32 v26, 16, v17
    v_and_b32 v27, s38, v17
    v_lshlrev_b32 v28, 16, v18
    v_and_b32 v29, s38, v18
    v_lshlrev_b32 v30, 16, v19
    v_and_b32 v31, s38, v19
    v_dot2c_f32_bf16 v24, s34, v20
    v_dot2c_f32_bf16 v25, s35, v20
    v_dot2c_f32_bf16 v26, s34, v21
    v_dot2c_f32_bf16 v27, s35, v21
    v_dot2c_f32_bf16 v28, s34, v20
    v_dot2c_f32_bf16 v29, s35, v20
    v_dot2c_f32_bf16 v30, s34, v21
    v_dot2c_f32_bf16 v31, s35, v21
    v_permlane32_swap_b32 v24, v26
    v_permlane32_swap_b32 v25, v27
    v_permlane32_swap_b32 v28, v30
    v_permlane32_swap_b32 v29, v31
    v_permlane16_swap_b32 v24, v25
    v_permlane16_swap_b32 v26, v27
    v_permlane16_swap_b32 v28, v29
    v_permlane16_swap_b32 v30, v31
    v_lshlrev_b32 v96, 16, v104
    v_and_b32 v97, s38, v104
    v_lshlrev_b32 v98, 16, v105
    v_and_b32 v99, s38, v105
    v_lshlrev_b32 v100, 16, v106
    v_and_b32 v101, s38, v106
    v_lshlrev_b32 v102, 16, v107
    v_and_b32 v103, s38, v107
    v_dot2c_f32_bf16 v96, s34, v22
    v_dot2c_f32_bf16 v97, s35, v22
    v_dot2c_f32_bf16 v98, s34, v23
    v_dot2c_f32_bf16 v99, s35, v23
    v_dot2c_f32_bf16 v100, s34, v22
    v_dot2c_f32_bf16 v101, s35, v22
    v_dot2c_f32_bf16 v102, s34, v23
    v_dot2c_f32_bf16 v103, s35, v23
    v_permlane32_swap_b32 v96, v98
    v_permlane32_swap_b32 v97, v99
    v_permlane32_swap_b32 v100, v102
    v_permlane32_swap_b32 v101, v103
    v_permlane16_swap_b32 v96, v97
    v_permlane16_swap_b32 v98, v99
    v_permlane16_swap_b32 v100, v101
    v_permlane16_swap_b32 v102, v103
    s_waitcnt vmcnt(1)
La0:
    v_cmp_eq_u32 vcc, 1, v9
    s_mov_b32 s32, s30
    s_and_b32 s37, vcc_lo, s36
    s_bitcmp1_b32 s37, 0
    s_cbranch_scc0 La00
    buffer_load_dwordx4 v[32:35], v7, s[12:15], s32 offen sc1
    buffer_load_dwordx4 v[36:39], v8, s[12:15], s32 offen sc1
La00:
    s_add_u32 s32, s32, 73728
    s_bitcmp1_b32 s37, 1
    s_cbranch_scc0 La01
    buffer_load_dwordx4 v[40:43], v7, s[12:15], s32 offen sc1
    buffer_load_dwordx4 v[44:47], v8, s[12:15], s32 offen sc1
La01:
    s_add_u32 s32, s32, 73728
    s_bitcmp1_b32 s37, 2
    s_cbranch_scc0 La02
    buffer_load_dwordx4 v[48:51], v7, s[12:15], s32 offen sc1
    buffer_load_dwordx4 v[52:55], v8, s[12:15], s32 offen sc1
La02:
    s_add_u32 s32, s32, 73728
    s_bitcmp1_b32 s37, 3
    s_cbranch_scc0 La03
    buffer_load_dwordx4 v[56:59], v7, s[12:15], s32 offen sc1
    buffer_load_dwordx4 v[60:63], v8, s[12:15], s32 offen sc1
La03:
    s_add_u32 s32, s32, 73728
    s_bitcmp1_b32 s37, 4
    s_cbranch_scc0 La04
    buffer_load_dwordx4 v[64:67], v7, s[12:15], s32 offen sc1
    buffer_load_dwordx4 v[68:71], v8, s[12:15], s32 offen sc1
La04:
    s_add_u32 s32, s32, 73728
    s_bitcmp1_b32 s37, 5
    s_cbranch_scc0 La05
    buffer_load_dwordx4 v[72:75], v7, s[12:15], s32 offen sc1
    buffer_load_dwordx4 v[76:79], v8, s[12:15], s32 offen sc1
La05:
    s_add_u32 s32, s32, 73728
    s_bitcmp1_b32 s37, 6
    s_cbranch_scc0 La06
    buffer_load_dwordx4 v[80:83], v7, s[12:15], s32 offen sc1
    buffer_load_dwordx4 v[84:87], v8, s[12:15], s32 offen sc1
La06:
    s_add_u32 s32, s32, 73728
    s_bitcmp1_b32 s37, 7
    s_cbranch_scc0 La07
    buffer_load_dwordx4 v[88:91], v7, s[12:15], s32 offen sc1
    buffer_load_dwordx4 v[92:95], v8, s[12:15], s32 offen sc1
La07:
    s_andn2_b32 s36, s36, s37
    s_cbranch_scc0 La1
    buffer_load_dword v9, v10, s[12:15], s29 offen sc1
La1:
    s_waitcnt vmcnt(0)
    s_bitcmp1_b32 s37, 0
    s_cbranch_scc0 La10
    v_dot2c_f32_bf16 v24, s34, v32
    v_dot2c_f32_bf16 v25, s35, v32
    v_dot2c_f32_bf16 v26, s34, v33
    v_dot2c_f32_bf16 v27, s35, v33
    v_dot2c_f32_bf16 v28, s34, v34
    v_dot2c_f32_bf16 v29, s35, v34
    v_dot2c_f32_bf16 v30, s34, v35
    v_dot2c_f32_bf16 v31, s35, v35
    v_dot2c_f32_bf16 v96, s34, v36
    v_dot2c_f32_bf16 v97, s35, v36
    v_dot2c_f32_bf16 v98, s34, v37
    v_dot2c_f32_bf16 v99, s35, v37
    v_dot2c_f32_bf16 v100, s34, v38
    v_dot2c_f32_bf16 v101, s35, v38
    v_dot2c_f32_bf16 v102, s34, v39
    v_dot2c_f32_bf16 v103, s35, v39
La10:
    s_bitcmp1_b32 s37, 1
    s_cbranch_scc0 La11
    v_dot2c_f32_bf16 v24, s34, v40
    v_dot2c_f32_bf16 v25, s35, v40
    v_dot2c_f32_bf16 v26, s34, v41
    v_dot2c_f32_bf16 v27, s35, v41
    v_dot2c_f32_bf16 v28, s34, v42
    v_dot2c_f32_bf16 v29, s35, v42
    v_dot2c_f32_bf16 v30, s34, v43
    v_dot2c_f32_bf16 v31, s35, v43
    v_dot2c_f32_bf16 v96, s34, v44
    v_dot2c_f32_bf16 v97, s35, v44
    v_dot2c_f32_bf16 v98, s34, v45
    v_dot2c_f32_bf16 v99, s35, v45
    v_dot2c_f32_bf16 v100, s34, v46
    v_dot2c_f32_bf16 v101, s35, v46
    v_dot2c_f32_bf16 v102, s34, v47
    v_dot2c_f32_bf16 v103, s35, v47
La11:
    s_bitcmp1_b32 s37, 2
    s_cbranch_scc0 La12
    v_dot2c_f32_bf16 v24, s34, v48
    v_dot2c_f32_bf16 v25, s35, v48
    v_dot2c_f32_bf16 v26, s34, v49
    v_dot2c_f32_bf16 v27, s35, v49
    v_dot2c_f32_bf16 v28, s34, v50
    v_dot2c_f32_bf16 v29, s35, v50
    v_dot2c_f32_bf16 v30, s34, v51
    v_dot2c_f32_bf16 v31, s35, v51
    v_dot2c_f32_bf16 v96, s34, v52
    v_dot2c_f32_bf16 v97, s35, v52
    v_dot2c_f32_bf16 v98, s34, v53
    v_dot2c_f32_bf16 v99, s35, v53
    v_dot2c_f32_bf16 v100, s34, v54
    v_dot2c_f32_bf16 v101, s35, v54
    v_dot2c_f32_bf16 v102, s34, v55
    v_dot2c_f32_bf16 v103, s35, v55
La12:
    s_bitcmp1_b32 s37, 3
    s_cbranch_scc0 La13
    v_dot2c_f32_bf16 v24, s34, v56
    v_dot2c_f32_bf16 v25, s35, v56
    v_dot2c_f32_bf16 v26, s34, v57
    v_dot2c_f32_bf16 v27, s35, v57
    v_dot2c_f32_bf16 v28, s34, v58
    v_dot2c_f32_bf16 v29, s35, v58
    v_dot2c_f32_bf16 v30, s34, v59
    v_dot2c_f32_bf16 v31, s35, v59
    v_dot2c_f32_bf16 v96, s34, v60
    v_dot2c_f32_bf16 v97, s35, v60
    v_dot2c_f32_bf16 v98, s34, v61
    v_dot2c_f32_bf16 v99, s35, v61
    v_dot2c_f32_bf16 v100, s34, v62
    v_dot2c_f32_bf16 v101, s35, v62
    v_dot2c_f32_bf16 v102, s34, v63
    v_dot2c_f32_bf16 v103, s35, v63
La13:
    s_bitcmp1_b32 s37, 4
    s_cbranch_scc0 La14
    v_dot2c_f32_bf16 v24, s34, v64
    v_dot2c_f32_bf16 v25, s35, v64
    v_dot2c_f32_bf16 v26, s34, v65
    v_dot2c_f32_bf16 v27, s35, v65
    v_dot2c_f32_bf16 v28, s34, v66
    v_dot2c_f32_bf16 v29, s35, v66
    v_dot2c_f32_bf16 v30, s34, v67
    v_dot2c_f32_bf16 v31, s35, v67
    v_dot2c_f32_bf16 v96, s34, v68
    v_dot2c_f32_bf16 v97, s35, v68
    v_dot2c_f32_bf16 v98, s34, v69
    v_dot2c_f32_bf16 v99, s35, v69
    v_dot2c_f32_bf16 v100, s34, v70
    v_dot2c_f32_bf16 v101, s35, v70
    v_dot2c_f32_bf16 v102, s34, v71
    v_dot2c_f32_bf16 v103, s35, v71
La14:
    s_bitcmp1_b32 s37, 5
    s_cbranch_scc0 La15
    v_dot2c_f32_bf16 v24, s34, v72
    v_dot2c_f32_bf16 v25, s35, v72
    v_dot2c_f32_bf16 v26, s34, v73
    v_dot2c_f32_bf16 v27, s35, v73
    v_dot2c_f32_bf16 v28, s34, v74
    v_dot2c_f32_bf16 v29, s35, v74
    v_dot2c_f32_bf16 v30, s34, v75
    v_dot2c_f32_bf16 v31, s35, v75
    v_dot2c_f32_bf16 v96, s34, v76
    v_dot2c_f32_bf16 v97, s35, v76
    v_dot2c_f32_bf16 v98, s34, v77
    v_dot2c_f32_bf16 v99, s35, v77
    v_dot2c_f32_bf16 v100, s34, v78
    v_dot2c_f32_bf16 v101, s35, v78
    v_dot2c_f32_bf16 v102, s34, v79
    v_dot2c_f32_bf16 v103, s35, v79
La15:
    s_bitcmp1_b32 s37, 6
    s_cbranch_scc0 La16
    v_dot2c_f32_bf16 v24, s34, v80
    v_dot2c_f32_bf16 v25, s35, v80
    v_dot2c_f32_bf16 v26, s34, v81
    v_dot2c_f32_bf16 v27, s35, v81
    v_dot2c_f32_bf16 v28, s34, v82
    v_dot2c_f32_bf16 v29, s35, v82
    v_dot2c_f32_bf16 v30, s34, v83
    v_dot2c_f32_bf16 v31, s35, v83
    v_dot2c_f32_bf16 v96, s34, v84
    v_dot2c_f32_bf16 v97, s35, v84
    v_dot2c_f32_bf16 v98, s34, v85
    v_dot2c_f32_bf16 v99, s35, v85
    v_dot2c_f32_bf16 v100, s34, v86
    v_dot2c_f32_bf16 v101, s35, v86
    v_dot2c_f32_bf16 v102, s34, v87
    v_dot2c_f32_bf16 v103, s35, v87
La16:
    s_bitcmp1_b32 s37, 7
    s_cbranch_scc0 La17
    v_dot2c_f32_bf16 v24, s34, v88
    v_dot2c_f32_bf16 v25, s35, v88
    v_dot2c_f32_bf16 v26, s34, v89
    v_dot2c_f32_bf16 v27, s35, v89
    v_dot2c_f32_bf16 v28, s34, v90
    v_dot2c_f32_bf16 v29, s35, v90
    v_dot2c_f32_bf16 v30, s34, v91
    v_dot2c_f32_bf16 v31, s35, v91
    v_dot2c_f32_bf16 v96, s34, v92
    v_dot2c_f32_bf16 v97, s35, v92
    v_dot2c_f32_bf16 v98, s34, v93
    v_dot2c_f32_bf16 v99, s35, v93
    v_dot2c_f32_bf16 v100, s34, v94
    v_dot2c_f32_bf16 v101, s35, v94
    v_dot2c_f32_bf16 v102, s34, v95
    v_dot2c_f32_bf16 v103, s35, v95
La17:
    s_sub_u32 s84, s84, 1
    s_cbranch_scc1 La2
    s_cmp_eq_u32 s36, 0
    s_cbranch_scc0 La0
La2:
    v_permlane32_swap_b32 v24, v26
    v_permlane32_swap_b32 v25, v27
    v_permlane32_swap_b32 v28, v30
    v_permlane32_swap_b32 v29, v31
    v_permlane16_swap_b32 v24, v25
    v_permlane16_swap_b32 v26, v27
    v_permlane16_swap_b32 v28, v29
    v_permlane16_swap_b32 v30, v31
    v_cvt_pk_bf16_f32 v24, v24, v25
    v_cvt_pk_bf16_f32 v25, v26, v27
    v_cvt_pk_bf16_f32 v26, v28, v29
    v_cvt_pk_bf16_f32 v27, v30, v31
    s_nop 0
    v_permlane16_swap_b32 v24, v26
    v_permlane16_swap_b32 v25, v27
    buffer_store_dwordx4 v[24:27], v2, s[16:19], s31 offen offset:0
    v_permlane32_swap_b32 v96, v98
    v_permlane32_swap_b32 v97, v99
    v_permlane32_swap_b32 v100, v102
    v_permlane32_swap_b32 v101, v103
    v_permlane16_swap_b32 v96, v97
    v_permlane16_swap_b32 v98, v99
    v_permlane16_swap_b32 v100, v101
    v_permlane16_swap_b32 v102, v103
    v_cvt_pk_bf16_f32 v96, v96, v97
    v_cvt_pk_bf16_f32 v97, v98, v99
    v_cvt_pk_bf16_f32 v98, v100, v101
    v_cvt_pk_bf16_f32 v99, v102, v103
    s_nop 0
    v_permlane16_swap_b32 v96, v98
    v_permlane16_swap_b32 v97, v99
    buffer_store_dwordx4 v[96:99], v2, s[16:19], s31 offen offset:96
    s_endpgm
Lloop:
    s_waitcnt lgkmcnt(0)
    v_mfma_f32_32x32x16_bf16 v[80:95], v[20:23], v[8:11], v[128:143]
    ds_read_b64 v[16:17], v2 offset:512
    ds_read_b64 v[18:19], v2 offset:4608
    ds_read_b64 v[28:29], v2 offset:8704
    s_cbranch_vccz Lp800
    s_setprio 0
Lp800:
    v_exp_f32 v64, v64
    v_exp_f32 v65, v65
    v_exp_f32 v66, v66
    v_exp_f32 v67, v67
    v_mfma_f32_32x32x8_bf16 v[80:95], v[26:27], v[12:13], v[80:95]
    s_mov_b64 exec, s[20:21]
    ds_read_b128 v[32:35], v3 offset:10240
    ds_read_b128 v[36:39], v3 offset:10816
    s_mov_b64 exec, -1
    v_exp_f32 v68, v68
    v_exp_f32 v69, v69
    v_exp_f32 v70, v70
    v_exp_f32 v71, v71
    v_smfmac_f32_32x32x32_bf16 v[48:63], v[40:43], v[112:119], v4
    v_exp_f32 v72, v72
    v_exp_f32 v73, v73
    v_exp_f32 v74, v74
    v_exp_f32 v75, v75
    v_smfmac_f32_32x32x32_bf16 v[48:63], v[44:47], v[120:127], v4
    v_exp_f32 v76, v76
    v_exp_f32 v77, v77
    v_exp_f32 v78, v78
    v_exp_f32 v79, v79
    s_waitcnt lgkmcnt(0)
    v_mfma_f32_32x32x16_bf16 v[96:111], v[16:19], v[8:11], v[128:143]
    ds_read_b64 v[20:21], v2 offset:768
    ds_read_b64 v[22:23], v2 offset:4864
    ds_read_b64 v[30:31], v2 offset:8960
    v_exp_f32 v80, v80
    v_exp_f32 v81, v81
    v_exp_f32 v82, v82
    v_exp_f32 v83, v83
    v_mfma_f32_32x32x8_bf16 v[96:111], v[28:29], v[12:13], v[96:111]
    s_mov_b64 exec, s[20:21]
    ds_read_b128 v[40:43], v3 offset:11392
    ds_read_b128 v[44:47], v3 offset:11968
    s_mov_b64 exec, -1
    v_exp_f32 v84, v84
    v_exp_f32 v85, v85
    v_exp_f32 v86, v86
    v_exp_f32 v87, v87
    v_smfmac_f32_32x32x32_bf16 v[48:63], v[32:35], v[64:71], v4
    v_exp_f32 v88, v88
    v_exp_f32 v89, v89
    v_exp_f32 v90, v90
    v_exp_f32 v91, v91
    v_smfmac_f32_32x32x32_bf16 v[48:63], v[36:39], v[72:79], v4
    v_exp_f32 v92, v92
    v_exp_f32 v93, v93
    v_exp_f32 v94, v94
    v_exp_f32 v95, v95
    s_waitcnt lgkmcnt(0)
    v_mfma_f32_32x32x16_bf16 v[112:127], v[20:23], v[8:11], v[128:143]
    ds_read_b64 v[16:17], v2 offset:2048
    ds_read_b64 v[18:19], v2 offset:6144
    v_exp_f32 v96, v96
    v_exp_f32 v97, v97
    v_exp_f32 v98, v98
    v_exp_f32 v99, v99
    v_mfma_f32_32x32x8_bf16 v[112:127], v[30:31], v[12:13], v[112:127]
    s_mov_b64 exec, s[20:21]
    ds_read_b128 v[32:35], v3 offset:12544
    ds_read_b128 v[36:39], v3 offset:13120
    s_mov_b64 exec, -1
    v_exp_f32 v100, v100
    v_exp_f32 v101, v101
    v_exp_f32 v102, v102
    v_exp_f32 v103, v103
    v_smfmac_f32_32x32x32_bf16 v[48:63], v[40:43], v[80:87], v4
    v_exp_f32 v104, v104
    v_exp_f32 v105, v105
    v_exp_f32 v106, v106
    v_exp_f32 v107, v107
    v_smfmac_f32_32x32x32_bf16 v[48:63], v[44:47], v[88:95], v4
    v_exp_f32 v108, v108
    v_exp_f32 v109, v109
    v_exp_f32 v110, v110
    v_exp_f32 v111, v111
    s_waitcnt lgkmcnt(0)
    v_mfma_f32_32x32x16_bf16 v[64:79], v[16:19], v[8:11], v[128:143]
    ds_read_b64 v[20:21], v2 offset:2304
    ds_read_b64 v[22:23], v2 offset:6400
    v_exp_f32 v112, v112
    v_exp_f32 v113, v113
    v_exp_f32 v114, v114
    v_exp_f32 v115, v115
    v_mfma_f32_32x32x8_bf16 v[64:79], v[24:25], v[14:15], v[64:79]
    s_mov_b64 exec, s[20:21]
    ds_read_b128 v[40:43], v3 offset:13696
    ds_read_b128 v[44:47], v3 offset:14272
    s_mov_b64 exec, -1
    v_exp_f32 v116, v116
    v_exp_f32 v117, v117
    v_exp_f32 v118, v118
    v_exp_f32 v119, v119
    v_smfmac_f32_32x32x32_bf16 v[48:63], v[32:35], v[96:103], v4
    v_exp_f32 v120, v120
    v_exp_f32 v121, v121
    v_exp_f32 v122, v122
    v_exp_f32 v123, v123
    v_smfmac_f32_32x32x32_bf16 v[48:63], v[36:39], v[104:111], v4
    v_exp_f32 v124, v124
    v_exp_f32 v125, v125
    v_exp_f32 v126, v126
    v_exp_f32 v127, v127
    s_waitcnt lgkmcnt(0)
    v_mfma_f32_32x32x16_bf16 v[80:95], v[20:23], v[8:11], v[128:143]
    ds_read_b64 v[16:17], v2 offset:2560
    ds_read_b64 v[18:19], v2 offset:6656
    v_exp_f32 v64, v64
    v_exp_f32 v65, v65
    v_exp_f32 v66, v66
    v_exp_f32 v67, v67
    v_mfma_f32_32x32x8_bf16 v[80:95], v[26:27], v[14:15], v[80:95]
    s_mov_b64 exec, s[20:21]
    ds_read_b128 v[32:35], v3 offset:14848
    ds_read_b128 v[36:39], v3 offset:15424
    s_mov_b64 exec, -1
    v_exp_f32 v68, v68
    v_exp_f32 v69, v69
    v_exp_f32 v70, v70
    v_exp_f32 v71, v71
    v_smfmac_f32_32x32x32_bf16 v[48:63], v[40:43], v[112:119], v4
    s_cbranch_vccz Lp842
    s_setprio 2
Lp842:
    v_exp_f32 v72, v72
    v_exp_f32 v73, v73
    v_exp_f32 v74, v74
    v_exp_f32 v75, v75
    v_smfmac_f32_32x32x32_bf16 v[48:63], v[44:47], v[120:127], v4
    v_exp_f32 v76, v76
    v_exp_f32 v77, v77
    v_exp_f32 v78, v78
    v_exp_f32 v79, v79
    s_waitcnt lgkmcnt(0)
    v_mfma_f32_32x32x16_bf16 v[96:111], v[16:19], v[8:11], v[128:143]
    ds_read_b64 v[20:21], v2 offset:2816
    ds_read_b64 v[22:23], v2 offset:6912
    v_exp_f32 v80, v80
    v_exp_f32 v81, v81
    v_exp_f32 v82, v82
    v_exp_f32 v83, v83
    v_mfma_f32_32x32x8_bf16 v[96:111], v[28:29], v[14:15], v[96:111]
    s_mov_b64 exec, s[20:21]
    ds_read_b128 v[40:43], v3 offset:16000
    ds_read_b128 v[44:47], v3 offset:16576
    s_mov_b64 exec, -1
    v_exp_f32 v84, v84
    v_exp_f32 v85, v85
    v_exp_f32 v86, v86
    v_exp_f32 v87, v87
    v_smfmac_f32_32x32x32_bf16 v[48:63], v[32:35], v[64:71], v4
    v_exp_f32 v88, v88
    v_exp_f32 v89, v89
    v_exp_f32 v90, v90
    v_exp_f32 v91, v91
    v_smfmac_f32_32x32x32_bf16 v[48:63], v[36:39], v[72:79], v4
    v_exp_f32 v92, v92
    v_exp_f32 v93, v93
    v_exp_f32 v94, v94
    v_exp_f32 v95, v95
    s_waitcnt lgkmcnt(0)
    v_mfma_f32_32x32x16_bf16 v[112:127], v[20:23], v[8:11], v[128:143]
    ds_read_b64 v[16:17], v2 offset:19456
    ds_read_b64 v[18:19], v2 offset:23552
    ds_read_b64 v[24:25], v2 offset:27648
    v_exp_f32 v96, v96
    v_exp_f32 v97, v97
    v_exp_f32 v98, v98
    v_exp_f32 v99, v99
    v_mfma_f32_32x32x8_bf16 v[112:127], v[30:31], v[14:15], v[112:127]
    s_mov_b64 exec, s[20:21]
    ds_read_b128 v[32:35], v3 offset:17152
    ds_read_b128 v[36:39], v3 offset:17728
    s_mov_b64 exec, -1
    v_exp_f32 v100, v100
    v_exp_f32 v101, v101
    v_exp_f32 v102, v102
    v_exp_f32 v103, v103
    v_smfmac_f32_32x32x32_bf16 v[48:63], v[40:43], v[80:87], v4
    v_exp_f32 v104, v104
    v_exp_f32 v105, v105
    v_exp_f32 v106, v106
    v_exp_f32 v107, v107
    v_smfmac_f32_32x32x32_bf16 v[48:63], v[44:47], v[88:95], v4
    v_exp_f32 v108, v108
    v_exp_f32 v109, v109
    v_exp_f32 v110, v110
    v_exp_f32 v111, v111
    s_waitcnt lgkmcnt(0)
    v_mfma_f32_32x32x16_bf16 v[64:79], v[16:19], v[8:11], v[128:143]
    ds_read_b64 v[20:21], v2 offset:19712
    ds_read_b64 v[22:23], v2 offset:23808
    ds_read_b64 v[26:27], v2 offset:27904
    v_exp_f32 v112, v112
    v_exp_f32 v113, v113
    v_exp_f32 v114, v114
    v_exp_f32 v115, v115
    v_mfma_f32_32x32x8_bf16 v[64:79], v[24:25], v[12:13], v[64:79]
    s_mov_b64 exec, s[20:21]
    ds_read_b128 v[40:43], v3 offset:18304
    ds_read_b128 v[44:47], v3 offset:18880
    s_mov_b64 exec, -1
    v_exp_f32 v116, v116
    v_exp_f32 v117, v117
    v_exp_f32 v118, v118
    v_exp_f32 v119, v119
    v_smfmac_f32_32x32x32_bf16 v[48:63], v[32:35], v[96:103], v4
    v_add_u32 v2, 19456, v2
    v_add_u32 v3, 19456, v3
    s_add_u32 s22, s22, 1
    s_cmp_lt_u32 s22, s23
    v_exp_f32 v120, v120
    v_exp_f32 v121, v121
    v_exp_f32 v122, v122
    v_exp_f32 v123, v123
    v_smfmac_f32_32x32x32_bf16 v[48:63], v[36:39], v[104:111], v4
    v_exp_f32 v124, v124
    v_exp_f32 v125, v125
    v_exp_f32 v126, v126
    v_exp_f32 v127, v127
    s_cbranch_scc1 Lloop
    s_branch Lpost
Lslow:
    v_subrev_u32 v2, 155648, v2
    v_mov_b32 v5, 0xff800000
    s_mov_b32 s22, 0
Lmx:
    ds_read_b64 v[16:17], v2
    ds_read_b64 v[18:19], v2 offset:4096
    ds_read_b64 v[20:21], v2 offset:2048
    ds_read_b64 v[22:23], v2 offset:6144
    ds_read_b64 v[24:25], v2 offset:8192
    s_add_u32 s22, s22, 1
    s_and_b32 s32, s22, 3
    s_cmp_eq_u32 s32, 0
    s_movk_i32 s33, 256
    s_cselect_b32 s32, 18688, s33
    s_waitcnt lgkmcnt(0)
    v_mfma_f32_32x32x16_bf16 v[64:79], v[16:19], v[8:11], 0
    v_mfma_f32_32x32x16_bf16 v[80:95], v[20:23], v[8:11], 0
    v_mfma_f32_32x32x8_bf16 v[64:79], v[24:25], v[12:13], v[64:79]
    v_mfma_f32_32x32x8_bf16 v[80:95], v[24:25], v[14:15], v[80:95]
    v_add_u32 v2, s32, v2
    s_cmp_lt_u32 s22, 32
    s_nop 9
    v_max3_f32 v5, v5, v64, v80
    v_max3_f32 v5, v5, v65, v81
    v_max3_f32 v5, v5, v66, v82
    v_max3_f32 v5, v5, v67, v83
    v_max3_f32 v5, v5, v68, v84
    v_max3_f32 v5, v5, v69, v85
    v_max3_f32 v5, v5, v70, v86
    v_max3_f32 v5, v5, v71, v87
    v_max3_f32 v5, v5, v72, v88
    v_max3_f32 v5, v5, v73, v89
    v_max3_f32 v5, v5, v74, v90
    v_max3_f32 v5, v5, v75, v91
    v_max3_f32 v5, v5, v76, v92
    v_max3_f32 v5, v5, v77, v93
    v_max3_f32 v5, v5, v78, v94
    v_max3_f32 v5, v5, v79, v95
    s_cbranch_scc1 Lmx
    v_mov_b32 v6, v5
    s_nop 1
    v_permlane32_swap_b32 v5, v6
    s_mov_b32 s22, 8
    s_mov_b32 s23, 16
    v_max_f32 v5, v5, v6
    v_sub_f32 v128, 0, v5
    v_sub_f32 v129, 0, v5
    v_sub_f32 v130, 0, v5
    v_sub_f32 v131, 0, v5
    v_sub_f32 v132, 0, v5
    v_sub_f32 v133, 0, v5
    v_sub_f32 v134, 0, v5
    v_sub_f32 v135, 0, v5
    v_sub_f32 v136, 0, v5
    v_sub_f32 v137, 0, v5
    v_sub_f32 v138, 0, v5
    v_sub_f32 v139, 0, v5
    v_sub_f32 v140, 0, v5
    v_sub_f32 v141, 0, v5
    v_sub_f32 v142, 0, v5
    v_sub_f32 v143, 0, v5
Lcode_end:
    s_branch Lrestart
.section .rodata,"a"
.p2align 6
.amdhsa_kernel sequential_preLN__mha_block__dense_activation_gelu__prompt_kernel
  .amdhsa_next_free_vgpr 252
  .amdhsa_next_free_sgpr 102
  .amdhsa_accum_offset 252
  .amdhsa_group_segment_fixed_size 0
  .amdhsa_kernarg_size 88
  .amdhsa_user_sgpr_count 2
  .amdhsa_user_sgpr_kernarg_segment_ptr 1
  .amdhsa_system_sgpr_workgroup_id_x 1
.end_amdhsa_kernel
```
